```python
import torch

def _softmax(x, axis=-1):
    return torch.softmax(x, dim=axis)
def _gelu(x):
    return torch.nn.functional.gelu(x, approximate="tanh")
def _silu(x):
    return torch.nn.functional.silu(x)
def _sigmoid(x):
    return torch.sigmoid(x)
def _layernorm(x, axis=-1, eps=1e-5):
    m = x.mean(dim=axis, keepdim=True)
    v = x.var(dim=axis, keepdim=True, unbiased=False)
    return (x - m) / torch.sqrt(v + eps)
def _scatter_add(tgt, idx, src, axis=0):
    return tgt.clone().index_add_(axis, idx, src)
def _segment_sum(src, seg, n):
    out = torch.zeros((n,) + src.shape[1:], dtype=src.dtype)
    return out.index_add_(0, seg, src)
def _pad(x, pw):
    flat = tuple(v for pair in reversed(pw) for v in pair)
    return torch.nn.functional.pad(x, flat)

kernel_name = 'gated_mix__gqa_block_cached__swiglu_ffn__decode'

def setup_inputs():

    _w = (lambda a: (lambda t: t.to(torch.bfloat16) if t.is_floating_point() else t)(torch.as_tensor(a)))
    def _A_setup():
        B, Sq, D = 4, 1, 512
        Hq, Hkv, Sk, Dh = 32, 8, 4096, 128
        assert Hq % Hkv == 0, (Hq, Hkv)
        return {
            "x": _w((lambda *s: torch.randn(*s, dtype=torch.bfloat16) * 0.05)(B, Sq, D)),
            "k_cache": _w((lambda *s: torch.randn(*s, dtype=torch.bfloat16) * 6.4)(B, Hkv, Sk, Dh)),
            "v_cache": _w((lambda *s: torch.randn(*s, dtype=torch.bfloat16) * 0.2)(B, Hkv, Sk, Dh)),
            "wq": _w((lambda *s: torch.randn(*s, dtype=torch.bfloat16) * 6.4)(D, Hq * Dh) * (D ** -0.5)),
            "wo": _w((lambda *s: torch.randn(*s, dtype=torch.bfloat16) * 0.2)(Hq * Dh, D) * ((Hq * Dh) ** -0.5)),
        }
    _A_in = _A_setup()

    def _B_setup():
        B, S, D, F = 4, 1, 512, 1792
        return {
            "x": _w((lambda *s: torch.randn(*s, dtype=torch.bfloat16) * 0.05)(B, S, D)),
            "w_gate": _w((lambda *s: torch.randn(*s, dtype=torch.bfloat16) * 0.05)(D, F)),
            "w_up": _w((lambda *s: torch.randn(*s, dtype=torch.bfloat16) * 0.05)(D, F)),
            "w_down": _w((lambda *s: torch.randn(*s, dtype=torch.bfloat16) * 0.05)(F, D)),
        }
    _B_in = _B_setup()

    return {
        "A_x": _A_in["x"],
        "A_k_cache": _A_in["k_cache"],
        "A_v_cache": _A_in["v_cache"],
        "A_wq": _A_in["wq"],
        "A_wo": _A_in["wo"],
        "B_x": _B_in["x"],
        "B_w_gate": _B_in["w_gate"],
        "B_w_up": _B_in["w_up"],
        "B_w_down": _B_in["w_down"],
        "gate_w": _w((lambda *s: torch.randn(*s, dtype=torch.bfloat16) * 0.05)(512) * 16.0),
    }

def reference(A_x, A_k_cache, A_v_cache, A_wq, A_wo, B_x, B_w_gate, B_w_up, B_w_down, gate_w):
    def _A_ref(x, k_cache, v_cache, wq, wo):
        B, Sq, D = x.shape
        Hq, Dh = 32, 128
        Hkv = k_cache.shape[1]
        rep = Hq // Hkv
        q = (lambda x, *d: x.permute(*d))((x @ wq).reshape(B, Sq, Hq, Dh), 0, 2, 1, 3)
        k = (lambda x, n, axis: torch.repeat_interleave(x, n, dim=axis))(k_cache, rep, axis=1)
        v = (lambda x, n, axis: torch.repeat_interleave(x, n, dim=axis))(v_cache, rep, axis=1)
        scores = torch.einsum("bhqd,bhkd->bhqk", q, k) * (Dh ** -0.5)
        p = _softmax(scores, axis=-1)
        o = torch.einsum("bhqk,bhkd->bhqd", p, v)
        return (lambda x, *d: x.permute(*d))(o, 0, 2, 1, 3).reshape(B, Sq, Hq * Dh) @ wo

    def _B_ref(x, w_gate, w_up, w_down):
        g = _silu(x @ w_gate)
        u = x @ w_up
        return (g * u) @ w_down

    x = A_x
    g = _sigmoid((x * gate_w).sum(-1, keepdims=True))
    a = _A_ref(x, A_k_cache, A_v_cache, A_wq, A_wo)
    b = _B_ref(x, B_w_gate, B_w_up, B_w_down)
    return g * a + (1 - g) * b
```

```asm
; @launch grid=(256,1,1) block=(576,1,1) lds=65536
.amdgcn_target "amdgcn-amd-amdhsa--gfx950"
.text
.globl gated_mix__gqa_block_cached__swiglu_ffn__decode_kernel
.p2align 12
.fill 832, 4, 0xbf800000
.p2align 8
.type gated_mix__gqa_block_cached__swiglu_ffn__decode_kernel,@function
gated_mix__gqa_block_cached__swiglu_ffn__decode_kernel:
  s_load_dwordx16 s[16:31], s[0:1], 0
  s_load_dwordx8 s[32:39], s[0:1], 64
  s_load_dwordx2 s[40:41], s[0:1], 96
  s_cmp_ge_u32 s2, 256
  s_cbranch_scc1 L_end
  v_lshrrev_b32 v1, 6, v0
  v_and_b32 v0, 63, v0
  s_and_b32 s3, s2, 7
  v_readfirstlane_b32 s7, v1
  s_lshr_b32 s4, s2, 3
  s_lshr_b32 s5, s4, 3
  s_and_b32 s6, s4, 7
  s_lshr_b32 s42, s4, 1
  s_lshr_b32 s65, s42, 2
  s_and_b32 s66, s42, 3
  s_and_b32 s67, s4, 1
  s_lshl_b32 s9, s3, 4
  s_add_u32 s64, s42, s9
  s_mul_i32 s43, s3, 14
  s_add_u32 s43, s43, s42
  s_cmp_eq_u32 s7, 0
  s_cbranch_scc1 L_helper
  s_sub_u32 s7, s7, 1
  v_lshrrev_b32 v3, 2, v0
  v_and_b32 v3, 3, v3
  v_lshlrev_b32 v3, 8, v3
  v_lshrrev_b32 v4, 4, v0
  v_lshlrev_b32 v4, 6, v4
  v_and_b32 v5, 3, v0
  v_lshlrev_b32 v5, 4, v5
  v_or_b32 v1, v3, v4
  v_or_b32 v1, v1, v5
  v_lshlrev_b32 v2, 4, v0
  s_lshl_b32 s9, s5, 3
  s_add_u32 s9, s9, s3
  s_lshl_b32 s9, s9, 20
  s_mov_b32 s10, 0
  s_bitcmp1_b32 s6, 0
  s_cselect_b32 s12, 0x400, 0
  s_xor_b32 s10, s10, s12
  s_bitcmp1_b32 s6, 1
  s_cselect_b32 s12, 0x800, 0
  s_xor_b32 s10, s10, s12
  s_bitcmp1_b32 s6, 2
  s_cselect_b32 s12, 0x1000, 0
  s_xor_b32 s10, s10, s12
  s_bitcmp1_b32 s7, 0
  s_cselect_b32 s12, 0x10000, 0
  s_xor_b32 s10, s10, s12
  s_bitcmp1_b32 s7, 1
  s_cselect_b32 s12, 0x8000, 0
  s_xor_b32 s10, s10, s12
  s_bitcmp1_b32 s7, 2
  s_cselect_b32 s12, 0x40800, 0
  s_xor_b32 s10, s10, s12
  s_bitcmp1_b32 s5, 0
  s_cselect_b32 s12, 0x46000, 0
  s_xor_b32 s10, s10, s12
  s_bitcmp1_b32 s5, 1
  s_cselect_b32 s12, 0x2000, 0
  s_xor_b32 s10, s10, s12
  s_bitcmp1_b32 s3, 0
  s_cselect_b32 s12, 0xe2000, 0
  s_xor_b32 s10, s10, s12
  s_bitcmp1_b32 s3, 1
  s_cselect_b32 s12, 0x14000, 0
  s_xor_b32 s10, s10, s12
  s_bitcmp1_b32 s3, 2
  s_cselect_b32 s12, 0xe6000, 0
  s_xor_b32 s10, s10, s12
  s_add_u32 s9, s9, s10
  s_mov_b32 s10, 0
  s_add_u32 s14, s9, s10
  s_mov_b32 s11, s14
  s_waitcnt lgkmcnt(0)
  s_mov_b32 s44, s18
  s_mov_b32 s45, s19
  s_mov_b32 s46, 0x2000000
  s_mov_b32 s47, 0x00020000
  s_mov_b32 s48, s20
  s_mov_b32 s49, s21
  s_mov_b32 s50, 0x2000000
  s_mov_b32 s51, 0x00020000
  s_mov_b32 s52, s40
  s_mov_b32 s53, s41
  s_mov_b32 s54, 0x400000
  s_mov_b32 s55, 0x00020000
  s_barrier
  s_branch L_K
L_helper:
  s_setprio 3
  v_mov_b32 v1, 0x1900
  v_mov_b32 v2, 0
  v_mov_b32 v3, 0
  ds_write_b64 v1, v[2:3]
  v_mov_b32 v2, 0
  ds_write_b64 v1, v[2:3] offset:8
  v_lshlrev_b32 v4, 4, v0
  v_lshrrev_b32 v5, 3, v0
  v_and_b32 v6, 6, v5
  v_and_b32 v7, 7, v0
  v_xor_b32 v6, v6, v7
  v_lshlrev_b32 v6, 4, v6
  v_lshlrev_b32 v7, 13, v5
  v_add_u32 v7, v7, v6
  v_mul_u32_u24 v8, 3584, v5
  v_add_u32 v8, v8, v6
  s_and_b32 s9, s4, 3
  s_lshl_b32 s9, s9, 20
  s_lshl_b32 s10, s3, 10
  s_add_u32 s9, s9, s10
  s_lshr_b32 s10, s4, 2
  s_lshl_b32 s10, s10, 7
  s_add_u32 s14, s9, s10
  s_mov_b32 s50, 0x400000
  s_mov_b32 s51, 0x00020000
  s_mov_b32 s54, 0x400000
  s_mov_b32 s55, 0x00020000
  s_mov_b32 s46, 0x1000
  s_mov_b32 s47, 0x00020000
  s_mov_b32 m0, 0x2000
  s_waitcnt lgkmcnt(0)
  s_mov_b32 s48, s22
  s_mov_b32 s49, s23
  buffer_load_dwordx4 v7, s[48:51], s14 offen nt lds
  s_mov_b32 m0, 0x2400
  s_add_u32 s14, s14, 0x10000
  buffer_load_dwordx4 v7, s[48:51], s14 offen nt lds
  s_mov_b32 m0, 0x2800
  s_add_u32 s14, s14, 0x10000
  buffer_load_dwordx4 v7, s[48:51], s14 offen nt lds
  s_mov_b32 m0, 0x2c00
  s_add_u32 s14, s14, 0x10000
  buffer_load_dwordx4 v7, s[48:51], s14 offen nt lds
  s_mov_b32 m0, 0x3000
  s_add_u32 s14, s14, 0x10000
  buffer_load_dwordx4 v7, s[48:51], s14 offen nt lds
  s_mov_b32 m0, 0x3400
  s_add_u32 s14, s14, 0x10000
  buffer_load_dwordx4 v7, s[48:51], s14 offen nt lds
  s_mov_b32 m0, 0x3800
  s_add_u32 s14, s14, 0x10000
  buffer_load_dwordx4 v7, s[48:51], s14 offen nt lds
  s_mov_b32 m0, 0x3c00
  s_add_u32 s14, s14, 0x10000
  buffer_load_dwordx4 v7, s[48:51], s14 offen nt lds
  s_mov_b32 m0, 0x4000
  s_add_u32 s14, s14, 0x10000
  buffer_load_dwordx4 v7, s[48:51], s14 offen nt lds
  s_mov_b32 m0, 0x4400
  s_add_u32 s14, s14, 0x10000
  buffer_load_dwordx4 v7, s[48:51], s14 offen nt lds
  s_mov_b32 m0, 0x4800
  s_add_u32 s14, s14, 0x10000
  buffer_load_dwordx4 v7, s[48:51], s14 offen nt lds
  s_mov_b32 m0, 0x4c00
  s_add_u32 s14, s14, 0x10000
  buffer_load_dwordx4 v7, s[48:51], s14 offen nt lds
  s_mov_b32 m0, 0x5000
  s_add_u32 s14, s14, 0x10000
  buffer_load_dwordx4 v7, s[48:51], s14 offen nt lds
  s_mov_b32 m0, 0x5400
  s_add_u32 s14, s14, 0x10000
  buffer_load_dwordx4 v7, s[48:51], s14 offen nt lds
  s_mov_b32 m0, 0x5800
  s_add_u32 s14, s14, 0x10000
  buffer_load_dwordx4 v7, s[48:51], s14 offen nt lds
  s_mov_b32 m0, 0x5c00
  s_add_u32 s14, s14, 0x10000
  buffer_load_dwordx4 v7, s[48:51], s14 offen nt lds
  s_barrier
  s_mov_b32 s52, s40
  s_mov_b32 s53, s41
  s_mov_b32 s44, s16
  s_mov_b32 s45, s17
  v_mov_b32 v3, 0
  s_mov_b32 m0, 0x0
  buffer_load_dword v2, v3, s[52:55], 0 offen sc1
  buffer_load_dwordx4 v4, s[44:47], 0 offen offset:0 lds
  s_mov_b32 m0, 0x20
  s_nop 0
  buffer_load_dwordx4 v4, s[44:47], 0 offen offset:1024 lds
  s_mov_b32 m0, 0x40
  s_nop 0
  buffer_load_dwordx4 v4, s[44:47], 0 offen offset:2048 lds
  s_mov_b32 m0, 0x60
  s_nop 0
  buffer_load_dwordx4 v4, s[44:47], 0 offen offset:3072 lds
  s_branch L_helper2
.p2align 6
L_K:
  s_setprio 2
  buffer_load_dwordx4 a[0:3], v1, s[44:47], s14 offen nt
  s_xor_b32 s12, s14, 0x24400
  buffer_load_dwordx4 a[4:7], v1, s[44:47], s12 offen nt
  s_xor_b32 s12, s14, 0x4c00
  buffer_load_dwordx4 a[8:11], v1, s[44:47], s12 offen nt
  s_xor_b32 s12, s14, 0x20800
  buffer_load_dwordx4 a[12:15], v1, s[44:47], s12 offen nt
  s_xor_b32 s12, s14, 0x93400
  buffer_load_dwordx4 a[16:19], v1, s[44:47], s12 offen nt
  s_xor_b32 s12, s14, 0xb7000
  buffer_load_dwordx4 a[20:23], v1, s[44:47], s12 offen nt
  s_xor_b32 s12, s14, 0x97800
  buffer_load_dwordx4 a[24:27], v1, s[44:47], s12 offen nt
  s_xor_b32 s12, s14, 0xb3c00
  buffer_load_dwordx4 a[28:31], v1, s[44:47], s12 offen nt
  s_xor_b32 s12, s14, 0x80400
  buffer_load_dwordx4 a[32:35], v1, s[44:47], s12 offen nt
  s_xor_b32 s12, s14, 0xa4000
  buffer_load_dwordx4 a[36:39], v1, s[44:47], s12 offen nt
  s_xor_b32 s12, s14, 0x84800
  buffer_load_dwordx4 a[40:43], v1, s[44:47], s12 offen nt
  s_xor_b32 s12, s14, 0xa0c00
  buffer_load_dwordx4 a[44:47], v1, s[44:47], s12 offen nt
  s_xor_b32 s12, s14, 0x13000
  buffer_load_dwordx4 a[48:51], v1, s[44:47], s12 offen nt
  s_xor_b32 s12, s14, 0x37400
  buffer_load_dwordx4 a[52:55], v1, s[44:47], s12 offen nt
  s_xor_b32 s12, s14, 0x17c00
  buffer_load_dwordx4 a[56:59], v1, s[44:47], s12 offen nt
  s_xor_b32 s12, s14, 0x33800
  buffer_load_dwordx4 a[60:63], v1, s[44:47], s12 offen nt
  s_setprio 0
  buffer_load_dwordx4 v[40:43], v2, s[48:51], s11 offen nt
  s_xor_b32 s12, s11, 0x24400
  buffer_load_dwordx4 v[44:47], v2, s[48:51], s12 offen nt
  s_xor_b32 s12, s11, 0x4c00
  buffer_load_dwordx4 v[48:51], v2, s[48:51], s12 offen nt
  s_xor_b32 s12, s11, 0x20800
  buffer_load_dwordx4 v[52:55], v2, s[48:51], s12 offen nt
  s_xor_b32 s12, s11, 0x93400
  buffer_load_dwordx4 v[56:59], v2, s[48:51], s12 offen nt
  s_xor_b32 s12, s11, 0xb7000
  buffer_load_dwordx4 v[60:63], v2, s[48:51], s12 offen nt
  s_xor_b32 s12, s11, 0x97800
  buffer_load_dwordx4 v[64:67], v2, s[48:51], s12 offen nt
  s_xor_b32 s12, s11, 0xb3c00
  buffer_load_dwordx4 v[68:71], v2, s[48:51], s12 offen nt
  s_xor_b32 s12, s11, 0x80400
  buffer_load_dwordx4 v[72:75], v2, s[48:51], s12 offen nt
  s_xor_b32 s12, s11, 0xa4000
  buffer_load_dwordx4 v[76:79], v2, s[48:51], s12 offen nt
  s_xor_b32 s12, s11, 0x84800
  buffer_load_dwordx4 v[80:83], v2, s[48:51], s12 offen nt
  s_xor_b32 s12, s11, 0xa0c00
  buffer_load_dwordx4 v[84:87], v2, s[48:51], s12 offen nt
  s_xor_b32 s12, s11, 0x13000
  buffer_load_dwordx4 v[88:91], v2, s[48:51], s12 offen nt
  s_xor_b32 s12, s11, 0x37400
  buffer_load_dwordx4 v[92:95], v2, s[48:51], s12 offen nt
  s_xor_b32 s12, s11, 0x17c00
  buffer_load_dwordx4 v[96:99], v2, s[48:51], s12 offen nt
  s_xor_b32 s12, s11, 0x33800
  buffer_load_dwordx4 v[100:103], v2, s[48:51], s12 offen nt
  v_mov_b32 v1, 0x1900
  v_mov_b32 v2, 1
  s_mov_b64 exec, 1
  ds_add_u32 v1, v2 offset:8
  s_mov_b64 exec, -1
  v_lshrrev_b32 v3, 2, v0
  v_and_b32 v3, 3, v3
  v_lshrrev_b32 v8, 4, v0
  v_xor_b32 v8, v8, v3
  v_lshlrev_b32 v8, 6, v8
  v_lshlrev_b32 v3, 8, v3
  v_add_u32 v3, v3, v8
  v_and_b32 v8, 3, v0
  v_lshlrev_b32 v8, 4, v8
  v_add_u32 v3, v3, v8
  s_mov_b32 s13, 400000
L_qspin_1:
  ds_read_b64 v[8:9], v1
  ds_read_b128 v[4:7], v3 offset:5376
  s_waitcnt lgkmcnt(0)
  v_readfirstlane_b32 s9, v8
  v_readfirstlane_b32 s8, v9
  s_cmp_lg_u32 s9, 0
  s_cbranch_scc1 L_qdone_2
  s_sleep 2
  s_sub_u32 s13, s13, 1
  s_cmp_lg_u32 s13, 0
  s_cbranch_scc1 L_qspin_1
L_qdone_2:
  s_lshr_b32 s76, s9, 1
  s_mul_i32 s15, s8, 0x85ebca6b
  s_bfe_u32 s72, s8, 0x80000
  s_bfe_u32 s9, s15, 0x20018
  s_lshl_b32 s9, s9, 8
  s_or_b32 s72, s72, s9
  s_bfe_u32 s73, s8, 0x80008
  s_bfe_u32 s9, s15, 0x2001a
  s_lshl_b32 s9, s9, 8
  s_or_b32 s73, s73, s9
  s_bfe_u32 s74, s8, 0x80010
  s_bfe_u32 s9, s15, 0x2001c
  s_lshl_b32 s9, s9, 8
  s_or_b32 s74, s74, s9
  s_bfe_u32 s75, s8, 0x80018
  s_bfe_u32 s9, s15, 0x2001e
  s_lshl_b32 s9, s9, 8
  s_or_b32 s75, s75, s9
  s_waitcnt vmcnt(16)
  v_mfma_f32_16x16x32_bf16 v[8:11], a[0:3], v[4:7], 0
  v_mfma_f32_16x16x32_bf16 v[12:15], a[4:7], v[4:7], 0
  v_mfma_f32_16x16x32_bf16 v[16:19], a[8:11], v[4:7], 0
  v_mfma_f32_16x16x32_bf16 v[20:23], a[12:15], v[4:7], 0
  s_nop 4
  v_mov_b32_dpp v24, v8 quad_perm:[0,0,0,0] row_mask:0xf bank_mask:0xf
  v_mov_b32_dpp v25, v12 quad_perm:[0,0,0,0] row_mask:0xf bank_mask:0xf
  s_nop 0
  v_add_f32_dpp v24, v9, v24 quad_perm:[1,1,1,1] row_mask:0xf bank_mask:0xf
  v_add_f32_dpp v25, v13, v25 quad_perm:[1,1,1,1] row_mask:0xf bank_mask:0xf
  s_nop 0
  v_add_f32_dpp v24, v10, v24 quad_perm:[2,2,2,2] row_mask:0xf bank_mask:0xf
  v_add_f32_dpp v25, v14, v25 quad_perm:[2,2,2,2] row_mask:0xf bank_mask:0xf
  s_nop 0
  v_add_f32_dpp v24, v11, v24 quad_perm:[3,3,3,3] row_mask:0xf bank_mask:0xf
  v_add_f32_dpp v25, v15, v25 quad_perm:[3,3,3,3] row_mask:0xf bank_mask:0xf
  v_mfma_f32_16x16x32_bf16 v[8:11], a[16:19], v[4:7], 0
  v_mfma_f32_16x16x32_bf16 v[12:15], a[20:23], v[4:7], 0
  v_mov_b32_dpp v26, v16 quad_perm:[0,0,0,0] row_mask:0xf bank_mask:0xf
  v_mov_b32_dpp v27, v20 quad_perm:[0,0,0,0] row_mask:0xf bank_mask:0xf
  s_nop 0
  v_add_f32_dpp v26, v17, v26 quad_perm:[1,1,1,1] row_mask:0xf bank_mask:0xf
  v_add_f32_dpp v27, v21, v27 quad_perm:[1,1,1,1] row_mask:0xf bank_mask:0xf
  s_nop 0
  v_add_f32_dpp v26, v18, v26 quad_perm:[2,2,2,2] row_mask:0xf bank_mask:0xf
  v_add_f32_dpp v27, v22, v27 quad_perm:[2,2,2,2] row_mask:0xf bank_mask:0xf
  s_nop 0
  v_add_f32_dpp v26, v19, v26 quad_perm:[3,3,3,3] row_mask:0xf bank_mask:0xf
  v_add_f32_dpp v27, v23, v27 quad_perm:[3,3,3,3] row_mask:0xf bank_mask:0xf
  v_mfma_f32_16x16x32_bf16 v[16:19], a[24:27], v[4:7], 0
  v_mfma_f32_16x16x32_bf16 v[20:23], a[28:31], v[4:7], 0
  v_mov_b32_dpp v28, v8 quad_perm:[0,0,0,0] row_mask:0xf bank_mask:0xf
  v_mov_b32_dpp v29, v12 quad_perm:[0,0,0,0] row_mask:0xf bank_mask:0xf
  s_nop 0
  v_add_f32_dpp v28, v9, v28 quad_perm:[1,1,1,1] row_mask:0xf bank_mask:0xf
  v_add_f32_dpp v29, v13, v29 quad_perm:[1,1,1,1] row_mask:0xf bank_mask:0xf
  s_nop 0
  v_add_f32_dpp v28, v10, v28 quad_perm:[2,2,2,2] row_mask:0xf bank_mask:0xf
  v_add_f32_dpp v29, v14, v29 quad_perm:[2,2,2,2] row_mask:0xf bank_mask:0xf
  s_nop 0
  v_add_f32_dpp v28, v11, v28 quad_perm:[3,3,3,3] row_mask:0xf bank_mask:0xf
  v_add_f32_dpp v29, v15, v29 quad_perm:[3,3,3,3] row_mask:0xf bank_mask:0xf
  v_mfma_f32_16x16x32_bf16 v[8:11], a[32:35], v[4:7], 0
  v_mfma_f32_16x16x32_bf16 v[12:15], a[36:39], v[4:7], 0
  v_mov_b32_dpp v30, v16 quad_perm:[0,0,0,0] row_mask:0xf bank_mask:0xf
  v_mov_b32_dpp v31, v20 quad_perm:[0,0,0,0] row_mask:0xf bank_mask:0xf
  s_nop 0
  v_add_f32_dpp v30, v17, v30 quad_perm:[1,1,1,1] row_mask:0xf bank_mask:0xf
  v_add_f32_dpp v31, v21, v31 quad_perm:[1,1,1,1] row_mask:0xf bank_mask:0xf
  s_nop 0
  v_add_f32_dpp v30, v18, v30 quad_perm:[2,2,2,2] row_mask:0xf bank_mask:0xf
  v_add_f32_dpp v31, v22, v31 quad_perm:[2,2,2,2] row_mask:0xf bank_mask:0xf
  s_nop 0
  v_add_f32_dpp v30, v19, v30 quad_perm:[3,3,3,3] row_mask:0xf bank_mask:0xf
  v_add_f32_dpp v31, v23, v31 quad_perm:[3,3,3,3] row_mask:0xf bank_mask:0xf
  v_mfma_f32_16x16x32_bf16 v[16:19], a[40:43], v[4:7], 0
  v_mfma_f32_16x16x32_bf16 v[20:23], a[44:47], v[4:7], 0
  v_mov_b32_dpp v32, v8 quad_perm:[0,0,0,0] row_mask:0xf bank_mask:0xf
  v_mov_b32_dpp v33, v12 quad_perm:[0,0,0,0] row_mask:0xf bank_mask:0xf
  s_nop 0
  v_add_f32_dpp v32, v9, v32 quad_perm:[1,1,1,1] row_mask:0xf bank_mask:0xf
  v_add_f32_dpp v33, v13, v33 quad_perm:[1,1,1,1] row_mask:0xf bank_mask:0xf
  s_nop 0
  v_add_f32_dpp v32, v10, v32 quad_perm:[2,2,2,2] row_mask:0xf bank_mask:0xf
  v_add_f32_dpp v33, v14, v33 quad_perm:[2,2,2,2] row_mask:0xf bank_mask:0xf
  s_nop 0
  v_add_f32_dpp v32, v11, v32 quad_perm:[3,3,3,3] row_mask:0xf bank_mask:0xf
  v_add_f32_dpp v33, v15, v33 quad_perm:[3,3,3,3] row_mask:0xf bank_mask:0xf
  v_mfma_f32_16x16x32_bf16 v[8:11], a[48:51], v[4:7], 0
  v_mfma_f32_16x16x32_bf16 v[12:15], a[52:55], v[4:7], 0
  v_mov_b32_dpp v34, v16 quad_perm:[0,0,0,0] row_mask:0xf bank_mask:0xf
  v_mov_b32_dpp v35, v20 quad_perm:[0,0,0,0] row_mask:0xf bank_mask:0xf
  s_nop 0
  v_add_f32_dpp v34, v17, v34 quad_perm:[1,1,1,1] row_mask:0xf bank_mask:0xf
  v_add_f32_dpp v35, v21, v35 quad_perm:[1,1,1,1] row_mask:0xf bank_mask:0xf
  s_nop 0
  v_add_f32_dpp v34, v18, v34 quad_perm:[2,2,2,2] row_mask:0xf bank_mask:0xf
  v_add_f32_dpp v35, v22, v35 quad_perm:[2,2,2,2] row_mask:0xf bank_mask:0xf
  s_nop 0
  v_add_f32_dpp v34, v19, v34 quad_perm:[3,3,3,3] row_mask:0xf bank_mask:0xf
  v_add_f32_dpp v35, v23, v35 quad_perm:[3,3,3,3] row_mask:0xf bank_mask:0xf
  v_mfma_f32_16x16x32_bf16 v[16:19], a[56:59], v[4:7], 0
  v_mfma_f32_16x16x32_bf16 v[20:23], a[60:63], v[4:7], 0
  v_mov_b32_dpp v36, v8 quad_perm:[0,0,0,0] row_mask:0xf bank_mask:0xf
  v_mov_b32_dpp v37, v12 quad_perm:[0,0,0,0] row_mask:0xf bank_mask:0xf
  s_nop 0
  v_add_f32_dpp v36, v9, v36 quad_perm:[1,1,1,1] row_mask:0xf bank_mask:0xf
  v_add_f32_dpp v37, v13, v37 quad_perm:[1,1,1,1] row_mask:0xf bank_mask:0xf
  s_nop 0
  v_add_f32_dpp v36, v10, v36 quad_perm:[2,2,2,2] row_mask:0xf bank_mask:0xf
  v_add_f32_dpp v37, v14, v37 quad_perm:[2,2,2,2] row_mask:0xf bank_mask:0xf
  s_nop 0
  v_add_f32_dpp v36, v11, v36 quad_perm:[3,3,3,3] row_mask:0xf bank_mask:0xf
  v_add_f32_dpp v37, v15, v37 quad_perm:[3,3,3,3] row_mask:0xf bank_mask:0xf
  v_mov_b32_dpp v38, v16 quad_perm:[0,0,0,0] row_mask:0xf bank_mask:0xf
  v_mov_b32_dpp v39, v20 quad_perm:[0,0,0,0] row_mask:0xf bank_mask:0xf
  s_nop 0
  v_add_f32_dpp v38, v17, v38 quad_perm:[1,1,1,1] row_mask:0xf bank_mask:0xf
  v_add_f32_dpp v39, v21, v39 quad_perm:[1,1,1,1] row_mask:0xf bank_mask:0xf
  s_nop 0
  v_add_f32_dpp v38, v18, v38 quad_perm:[2,2,2,2] row_mask:0xf bank_mask:0xf
  v_add_f32_dpp v39, v22, v39 quad_perm:[2,2,2,2] row_mask:0xf bank_mask:0xf
  s_nop 0
  v_add_f32_dpp v38, v19, v38 quad_perm:[3,3,3,3] row_mask:0xf bank_mask:0xf
  v_add_f32_dpp v39, v23, v39 quad_perm:[3,3,3,3] row_mask:0xf bank_mask:0xf
  s_mov_b32 s15, 0x3e0293ee
  v_max3_f32 v2, v24, v25, v26
  v_max3_f32 v1, v27, v28, v29
  v_max3_f32 v2, v2, v30, v31
  v_max3_f32 v1, v1, v32, v33
  v_max3_f32 v2, v2, v34, v35
  v_max3_f32 v1, v1, v36, v37
  v_max3_f32 v2, v2, v38, v39
  v_max_f32 v2, v2, v1
  v_mov_b32 v1, v2
  s_nop 1
  v_permlane16_swap_b32 v2, v1
  v_max_f32 v2, v2, v1
  v_mov_b32 v1, v2
  s_nop 1
  v_permlane32_swap_b32 v2, v1
  v_max_f32 v2, v2, v1
  v_mul_f32 v2, s15, v2
  v_fma_f32 v24, v24, s15, -v2
  v_fma_f32 v25, v25, s15, -v2
  v_fma_f32 v26, v26, s15, -v2
  v_fma_f32 v27, v27, s15, -v2
  v_fma_f32 v28, v28, s15, -v2
  v_fma_f32 v29, v29, s15, -v2
  v_fma_f32 v30, v30, s15, -v2
  v_fma_f32 v31, v31, s15, -v2
  v_fma_f32 v32, v32, s15, -v2
  v_fma_f32 v33, v33, s15, -v2
  v_fma_f32 v34, v34, s15, -v2
  v_fma_f32 v35, v35, s15, -v2
  v_fma_f32 v36, v36, s15, -v2
  v_fma_f32 v37, v37, s15, -v2
  v_fma_f32 v38, v38, s15, -v2
  v_fma_f32 v39, v39, s15, -v2
  v_exp_f32 v24, v24
  v_exp_f32 v25, v25
  v_exp_f32 v26, v26
  v_exp_f32 v27, v27
  v_exp_f32 v28, v28
  v_exp_f32 v29, v29
  v_exp_f32 v30, v30
  v_exp_f32 v31, v31
  v_exp_f32 v32, v32
  v_exp_f32 v33, v33
  v_exp_f32 v34, v34
  v_exp_f32 v35, v35
  v_exp_f32 v36, v36
  v_exp_f32 v37, v37
  v_exp_f32 v38, v38
  v_exp_f32 v39, v39
  v_add_f32 v3, v24, v25
  v_add_f32 v1, v26, v27
  v_add_f32 v3, v3, v28
  v_add_f32 v1, v1, v29
  v_add_f32 v3, v3, v30
  v_add_f32 v1, v1, v31
  v_add_f32 v3, v3, v32
  v_add_f32 v1, v1, v33
  v_add_f32 v3, v3, v34
  v_add_f32 v1, v1, v35
  v_add_f32 v3, v3, v36
  v_add_f32 v1, v1, v37
  v_add_f32 v3, v3, v38
  v_add_f32 v1, v1, v39
  v_add_f32 v3, v3, v1
  v_cvt_pk_bf16_f32 v24, v24, v25
  v_cvt_pk_bf16_f32 v25, v26, v27
  v_cvt_pk_bf16_f32 v26, v28, v29
  v_cvt_pk_bf16_f32 v27, v30, v31
  v_cvt_pk_bf16_f32 v28, v32, v33
  v_cvt_pk_bf16_f32 v29, v34, v35
  v_cvt_pk_bf16_f32 v30, v36, v37
  v_cvt_pk_bf16_f32 v31, v38, v39
  v_mov_b32 v1, v3
  s_nop 1
  v_permlane16_swap_b32 v3, v1
  v_add_f32 v3, v3, v1
  v_mov_b32 v1, v3
  s_nop 1
  v_permlane32_swap_b32 v3, v1
  v_add_f32 v3, v3, v1
  v_lshlrev_b32 v1, 4, v0
  s_lshl_b32 s9, s7, 3
  s_add_u32 s9, s9, 0x1a00
  v_add_u32 v1, s9, v1
  s_mov_b64 exec, 0x1111
  ds_write_b64 v1, v[2:3]
  s_mov_b64 exec, -1
  v_mov_b32 v37, 0x1900
  v_mov_b32 v38, 1
  s_mov_b64 exec, 1
  ds_add_u32 v37, v38 offset:12
  s_mov_b64 exec, -1
  s_mov_b32 s9, 0x05040100
  s_mov_b32 s10, 0x07060302
  s_waitcnt vmcnt(8)
  v_perm_b32 v8, v44, v40, s9
  v_perm_b32 v9, v52, v48, s9
  v_perm_b32 v10, v60, v56, s9
  v_perm_b32 v11, v68, v64, s9
  v_perm_b32 v12, v44, v40, s10
  v_perm_b32 v13, v52, v48, s10
  v_perm_b32 v14, v60, v56, s10
  v_perm_b32 v15, v68, v64, s10
  v_mfma_f32_16x16x32_bf16 a[0:3], v[24:27], v[8:11], 0
  v_perm_b32 v16, v45, v41, s9
  v_perm_b32 v17, v53, v49, s9
  v_perm_b32 v18, v61, v57, s9
  v_perm_b32 v19, v69, v65, s9
  v_mfma_f32_16x16x32_bf16 a[4:7], v[24:27], v[12:15], 0
  v_perm_b32 v20, v45, v41, s10
  v_perm_b32 v21, v53, v49, s10
  v_perm_b32 v22, v61, v57, s10
  v_perm_b32 v23, v69, v65, s10
  v_mfma_f32_16x16x32_bf16 a[8:11], v[24:27], v[16:19], 0
  v_perm_b32 v8, v46, v42, s9
  v_perm_b32 v9, v54, v50, s9
  v_perm_b32 v10, v62, v58, s9
  v_perm_b32 v11, v70, v66, s9
  v_mfma_f32_16x16x32_bf16 a[12:15], v[24:27], v[20:23], 0
  v_perm_b32 v12, v46, v42, s10
  v_perm_b32 v13, v54, v50, s10
  v_perm_b32 v14, v62, v58, s10
  v_perm_b32 v15, v70, v66, s10
  v_mfma_f32_16x16x32_bf16 a[16:19], v[24:27], v[8:11], 0
  v_perm_b32 v16, v47, v43, s9
  v_perm_b32 v17, v55, v51, s9
  v_perm_b32 v18, v63, v59, s9
  v_perm_b32 v19, v71, v67, s9
  v_mfma_f32_16x16x32_bf16 a[20:23], v[24:27], v[12:15], 0
  v_perm_b32 v20, v47, v43, s10
  v_perm_b32 v21, v55, v51, s10
  v_perm_b32 v22, v63, v59, s10
  v_perm_b32 v23, v71, v67, s10
  v_mfma_f32_16x16x32_bf16 a[24:27], v[24:27], v[16:19], 0
  s_nop 0
  v_mfma_f32_16x16x32_bf16 a[28:31], v[24:27], v[20:23], 0
  v_lshlrev_b32 v36, 2, v0
  s_lshl_b32 s58, s7, 11
  s_add_u32 s58, s58, 0x2000
  v_add_u32 v36, s58, v36
  v_mov_b32 v39, 0x3ff
  s_cmp_ge_u32 s7, 4
  s_cbranch_scc1 L_gpre_3
  v_lshrrev_b32 v7, 4, v0
  v_lshlrev_b32 v5, 14, v7
  v_lshlrev_b32 v6, 5, v7
  v_lshlrev_b32 v7, 6, v7
  v_and_b32 v4, 7, v0
  v_lshlrev_b32 v4, 3, v4
  v_add_u32 v7, v7, v4
  v_and_b32 v4, 14, v0
  v_lshlrev_b32 v4, 3, v4
  v_add_u32 v5, v5, v4
  v_and_b32 v4, 1, v0
  v_lshlrev_b32 v4, 4, v4
  v_add_u32 v6, v6, v4
  v_lshlrev_b32 v4, 2, v0
  s_lshl_b32 s58, s7, 9
  s_add_u32 s58, s58, 0x2000
  v_add_u32 v4, s58, v4
  s_lshl_b32 s59, s4, 7
  s_lshl_b32 s56, s3, 16
  s_lshl_b32 s58, s7, 12
  s_add_u32 s56, s56, s58
  s_add_u32 s56, s56, s59
  s_add_u32 s56, s56, 0x100000
  s_lshl_b32 s57, s3, 12
  s_add_u32 s57, s57, s59
  s_add_u32 s57, s57, 0x90000
  s_branch L_pvj_4
L_gpre_3:
  s_sub_u32 s58, s7, 4
  s_lshl_b32 s56, s3, 16
  s_lshl_b32 s59, s65, 14
  s_add_u32 s56, s56, s59
  s_lshl_b32 s59, s66, 12
  s_add_u32 s56, s56, s59
  s_lshl_b32 s59, s58, 10
  s_add_u32 s56, s56, s59
  s_add_u32 s56, s56, 0x100000
  s_lshl_b32 s57, s3, 12
  s_add_u32 s57, s57, s59
  s_lshl_b32 s59, s65, 5
  s_add_u32 s57, s57, s59
  s_add_u32 s57, s57, 0x90000
  v_lshlrev_b32 v4, 4, v0
  v_lshrrev_b32 v5, 3, v0
  v_lshlrev_b32 v5, 7, v5
  v_and_b32 v6, 3, v0
  v_lshlrev_b32 v6, 4, v6
  v_and_b32 v7, 4, v0
  v_lshlrev_b32 v7, 1, v7
  v_add_u32 v6, v6, v7
  v_lshrrev_b32 v7, 4, v0
  v_lshlrev_b32 v7, 1, v7
  v_add_u32 v6, v6, v7
  s_lshl_b32 s58, s58, 6
  s_add_u32 s58, s58, 0x1b00
  v_add_u32 v6, s58, v6
L_pvj_4:
  s_waitcnt vmcnt(6)
  v_perm_b32 v40, v76, v72, s9
  v_perm_b32 v44, v76, v72, s10
  v_perm_b32 v48, v77, v73, s9
  v_perm_b32 v52, v77, v73, s10
  v_perm_b32 v56, v78, v74, s9
  v_perm_b32 v60, v78, v74, s10
  v_perm_b32 v64, v79, v75, s9
  v_perm_b32 v68, v79, v75, s10
  s_waitcnt vmcnt(4)
  v_perm_b32 v41, v84, v80, s9
  v_perm_b32 v45, v84, v80, s10
  v_perm_b32 v49, v85, v81, s9
  v_perm_b32 v53, v85, v81, s10
  v_perm_b32 v57, v86, v82, s9
  v_perm_b32 v61, v86, v82, s10
  v_perm_b32 v65, v87, v83, s9
  v_perm_b32 v69, v87, v83, s10
  s_waitcnt vmcnt(2)
  v_perm_b32 v42, v92, v88, s9
  v_perm_b32 v46, v92, v88, s10
  v_perm_b32 v50, v93, v89, s9
  v_perm_b32 v54, v93, v89, s10
  v_perm_b32 v58, v94, v90, s9
  v_perm_b32 v62, v94, v90, s10
  v_perm_b32 v66, v95, v91, s9
  v_perm_b32 v70, v95, v91, s10
  s_waitcnt vmcnt(0)
  v_perm_b32 v43, v100, v96, s9
  v_perm_b32 v47, v100, v96, s10
  v_perm_b32 v51, v101, v97, s9
  v_mfma_f32_16x16x32_bf16 a[0:3], v[28:31], v[40:43], a[0:3]
  v_perm_b32 v55, v101, v97, s10
  v_mfma_f32_16x16x32_bf16 a[4:7], v[28:31], v[44:47], a[4:7]
  v_perm_b32 v59, v102, v98, s9
  v_mfma_f32_16x16x32_bf16 a[8:11], v[28:31], v[48:51], a[8:11]
  v_perm_b32 v63, v102, v98, s10
  v_mfma_f32_16x16x32_bf16 a[12:15], v[28:31], v[52:55], a[12:15]
  v_perm_b32 v67, v103, v99, s9
  v_mfma_f32_16x16x32_bf16 a[16:19], v[28:31], v[56:59], a[16:19]
  v_perm_b32 v71, v103, v99, s10
  v_mfma_f32_16x16x32_bf16 a[20:23], v[28:31], v[60:63], a[20:23]
  ds_write2st64_b32 v36, a0, a4 offset0:0 offset1:1
  v_mfma_f32_16x16x32_bf16 a[24:27], v[28:31], v[64:67], a[24:27]
  v_mfma_f32_16x16x32_bf16 a[28:31], v[28:31], v[68:71], a[28:31]
  s_nop 0
  ds_write2st64_b32 v36, a8, a12 offset0:2 offset1:3
  s_nop 2
  ds_write2st64_b32 v36, a16, a20 offset0:4 offset1:5
  s_nop 1
  ds_write2st64_b32 v36, a24, a28 offset0:6 offset1:7
  s_cmp_ge_u32 s7, 4
  s_cbranch_scc1 L_gath_5
  s_mov_b32 s13, 400000
L_sspin_6:
  ds_read_b32 v8, v37 offset:12
  ds_read_b64 v[10:11], v7 offset:6656
  s_waitcnt lgkmcnt(0)
  v_readfirstlane_b32 s58, v8
  s_nop 0
  s_cmp_ge_u32 s58, 8
  s_cbranch_scc1 L_sdone_7
  s_sleep 1
  s_sub_u32 s13, s13, 1
  s_cmp_lg_u32 s13, 0
  s_cbranch_scc1 L_sspin_6
L_sdone_7:
  v_mov_b32 v13, v10
  s_nop 1
  v_max_f32_dpp v13, v13, v13 row_ror:1 row_mask:0xf bank_mask:0xf
  s_nop 1
  v_max_f32_dpp v13, v13, v13 row_ror:2 row_mask:0xf bank_mask:0xf
  s_nop 1
  v_max_f32_dpp v13, v13, v13 row_ror:4 row_mask:0xf bank_mask:0xf
  v_sub_f32 v14, v10, v13
  v_exp_f32 v14, v14
  s_nop 0
  v_mul_f32 v15, v11, v14
  s_nop 1
  v_add_f32_dpp v15, v15, v15 row_ror:1 row_mask:0xf bank_mask:0xf
  s_nop 1
  v_add_f32_dpp v15, v15, v15 row_ror:2 row_mask:0xf bank_mask:0xf
  s_nop 1
  v_add_f32_dpp v15, v15, v15 row_ror:4 row_mask:0xf bank_mask:0xf
  s_cmp_lg_u32 s7, 0
  s_cbranch_scc1 L_nostat_8
  v_and_b32 v21, 0xfffffc00, v13
  v_and_b32 v23, 0xfffffc00, v15
  v_sub_f32 v21, v13, v21
  v_sub_f32 v23, v15, v23
  v_mov_b32 v20, v13
  v_mov_b32 v22, v15
  v_bfi_b32 v20, v39, s72, v20
  v_bfi_b32 v21, v39, s73, v21
  v_bfi_b32 v22, v39, s74, v22
  v_bfi_b32 v23, v39, s75, v23
  s_mov_b32 exec_lo, 0x00030003
  s_mov_b32 exec_hi, exec_lo
  s_cmp_eq_u32 s76, 0
  s_cbranch_scc1 L_slow_9
  buffer_store_dwordx4 v[20:23], v6, s[52:55], s57 offen
  s_branch L_pubd_10
L_slow_9:
  buffer_store_dwordx4 v[20:23], v6, s[52:55], s57 offen sc1
L_pubd_10:
  s_mov_b64 exec, -1
L_nostat_8:
  s_barrier
  ds_read2st64_b32 v[40:41], v4 offset0:0 offset1:1
  ds_read2st64_b32 v[42:43], v4 offset0:8 offset1:9
  ds_read2st64_b32 v[44:45], v4 offset0:16 offset1:17
  ds_read2st64_b32 v[46:47], v4 offset0:24 offset1:25
  ds_read2st64_b32 v[48:49], v4 offset0:32 offset1:33
  ds_read2st64_b32 v[50:51], v4 offset0:40 offset1:41
  ds_read2st64_b32 v[52:53], v4 offset0:48 offset1:49
  ds_read2st64_b32 v[54:55], v4 offset0:56 offset1:57
  s_waitcnt lgkmcnt(6)
  v_mul_f32_dpp v16, v14, v40 row_newbcast:0 row_mask:0xf bank_mask:0xf
  v_mul_f32_dpp v17, v14, v41 row_newbcast:0 row_mask:0xf bank_mask:0xf
  v_mul_f32_dpp v20, v14, v42 row_newbcast:1 row_mask:0xf bank_mask:0xf
  v_mul_f32_dpp v21, v14, v43 row_newbcast:1 row_mask:0xf bank_mask:0xf
  s_waitcnt lgkmcnt(4)
  v_fmac_f32_dpp v16, v14, v44 row_newbcast:2 row_mask:0xf bank_mask:0xf
  v_fmac_f32_dpp v17, v14, v45 row_newbcast:2 row_mask:0xf bank_mask:0xf
  v_fmac_f32_dpp v20, v14, v46 row_newbcast:3 row_mask:0xf bank_mask:0xf
  v_fmac_f32_dpp v21, v14, v47 row_newbcast:3 row_mask:0xf bank_mask:0xf
  s_waitcnt lgkmcnt(2)
  v_fmac_f32_dpp v16, v14, v48 row_newbcast:4 row_mask:0xf bank_mask:0xf
  v_fmac_f32_dpp v17, v14, v49 row_newbcast:4 row_mask:0xf bank_mask:0xf
  v_fmac_f32_dpp v20, v14, v50 row_newbcast:5 row_mask:0xf bank_mask:0xf
  v_fmac_f32_dpp v21, v14, v51 row_newbcast:5 row_mask:0xf bank_mask:0xf
  s_waitcnt lgkmcnt(0)
  v_fmac_f32_dpp v16, v14, v52 row_newbcast:6 row_mask:0xf bank_mask:0xf
  v_fmac_f32_dpp v17, v14, v53 row_newbcast:6 row_mask:0xf bank_mask:0xf
  v_fmac_f32_dpp v20, v14, v54 row_newbcast:7 row_mask:0xf bank_mask:0xf
  v_fmac_f32_dpp v21, v14, v55 row_newbcast:7 row_mask:0xf bank_mask:0xf
  v_pk_add_f32 v[16:17], v[16:17], v[20:21]
  v_add_u32 v16, 0x200, v16
  v_add_u32 v17, 0x200, v17
  s_nop 0
  v_mov_b32_dpp v18, v16 quad_perm:[1,0,3,2] row_mask:0xf bank_mask:0xf
  v_mov_b32_dpp v19, v17 quad_perm:[1,0,3,2] row_mask:0xf bank_mask:0xf
  v_bfi_b32 v16, v39, s72, v16
  v_bfi_b32 v17, v39, s73, v17
  v_bfi_b32 v18, v39, s74, v18
  v_bfi_b32 v19, v39, s75, v19
  s_mov_b32 exec_lo, 0x55555555
  s_mov_b32 exec_hi, exec_lo
  s_cmp_eq_u32 s76, 0
  s_cbranch_scc1 L_slow_11
  buffer_store_dwordx4 v[16:19], v5, s[52:55], s56 offen
  s_branch L_pubd_12
L_slow_11:
  buffer_store_dwordx4 v[16:19], v5, s[52:55], s56 offen sc1
L_pubd_12:
  s_mov_b64 exec, -1
  v_and_b32 v20, 3, v0
  v_lshrrev_b32 v21, 4, v0
  v_lshlrev_b32 v24, 6, v20
  v_lshlrev_b32 v25, 4, v21
  v_add_u32 v24, v24, v25
  v_lshlrev_b32 v25, 5, v20
  v_lshlrev_b32 v26, 3, v21
  v_add_u32 v25, v25, v26
  v_lshrrev_b32 v21, 2, v0
  v_and_b32 v22, 7, v21
  v_lshlrev_b32 v22, 1, v22
  v_lshrrev_b32 v23, 1, v20
  s_lshl_b32 s58, s7, 3
  v_add_u32 v23, s58, v23
  v_xor_b32 v23, v23, v22
  v_lshlrev_b32 v23, 4, v23
  v_lshlrev_b32 v21, 9, v21
  v_add_u32 v21, v21, v23
  v_and_b32 v20, 1, v20
  v_lshlrev_b32 v20, 3, v20
  v_add_u32 v20, v21, v20
  v_xor_b32 v21, 32, v20
  v_xor_b32 v22, 64, v20
  v_xor_b32 v23, 0x60, v20
  v_lshlrev_b32 v26, 4, v0
  s_lshl_b32 s56, s64, 13
  s_lshl_b32 s58, s67, 12
  s_add_u32 s56, s56, s58
  s_lshl_b32 s58, s7, 10
  s_add_u32 s56, s56, s58
  s_add_u32 s56, s56, 0x200000
  v_mov_b32 v27, 0x1910
  s_mov_b32 s16, 0x000f000f
  s_mov_b32 s17, s16
  s_lshl_b64 s[18:19], s[16:17], 4
  s_lshl_b64 s[20:21], s[18:19], 4
  s_lshl_b64 s[22:23], s[20:21], 4
  v_mov_b64 v[64:65], 0
  v_mov_b64 v[66:67], 0
  v_mov_b64 v[68:69], 0
  v_mov_b64 v[70:71], 0
  v_mov_b64 v[72:73], 0
  v_mov_b64 v[74:75], 0
  v_mov_b64 v[76:77], 0
  v_mov_b64 v[78:79], 0
  v_mov_b64 v[80:81], 0
  v_mov_b64 v[82:83], 0
  v_mov_b64 v[84:85], 0
  v_mov_b64 v[86:87], 0
  v_mov_b64 v[88:89], 0
  v_mov_b64 v[90:91], 0
  s_mov_b32 s13, 400000
L_wspin_13:
  ds_read_b32 v8, v37 offset:8
  s_waitcnt lgkmcnt(0)
  v_readfirstlane_b32 s58, v8
  s_nop 0
  s_cmp_ge_u32 s58, 0x100
  s_cbranch_scc1 L_wdone_14
  s_sub_u32 s13, s13, 1
  s_cmp_lg_u32 s13, 0
  s_cbranch_scc1 L_wspin_13
L_wdone_14:
  ds_read_b128 v[92:95], v27
  s_cmp_ge_u32 s42, 14
  s_cbranch_scc1 L_noffn3_15
  ds_read_b128 v[96:99], v27 offset:16
  ds_read_b64_tr_b16 v[56:57], v20 offset:57344
  ds_read_b64_tr_b16 v[58:59], v21 offset:57344
  ds_read_b64_tr_b16 v[60:61], v22 offset:57344
  ds_read_b64_tr_b16 v[62:63], v23 offset:57344
  s_mov_b64 exec, s[16:17]
  ds_read_b64 v[64:65], v25 offset:7168
  s_mov_b64 exec, s[18:19]
  ds_read_b64 v[66:67], v25 offset:7168
  s_mov_b64 exec, s[20:21]
  ds_read_b64 v[68:69], v25 offset:7168
  s_mov_b64 exec, s[22:23]
  ds_read_b64 v[70:71], v25 offset:7168
  s_mov_b64 exec, -1
  s_waitcnt lgkmcnt(0)
  s_nop 0
  v_mfma_f32_16x16x16_bf16 v[88:91], v[64:65], v[56:57], 0
  v_mfma_f32_16x16x16_bf16 v[88:91], v[66:67], v[58:59], v[88:91]
  v_mfma_f32_16x16x16_bf16 v[88:91], v[68:69], v[60:61], v[88:91]
  v_mfma_f32_16x16x16_bf16 v[88:91], v[70:71], v[62:63], v[88:91]
  s_nop 7
  v_mul_f32 v88, v88, v96
  v_mul_f32 v89, v89, v97
  v_mul_f32 v90, v90, v98
  v_mul_f32 v91, v91, v99
L_noffn3_15:
  s_mov_b32 s13, 400000
L_wspin_16:
  ds_read_b32 v8, v37 offset:8
  s_waitcnt lgkmcnt(0)
  v_readfirstlane_b32 s58, v8
  s_nop 0
  s_cmp_ge_u32 s58, 0x200
  s_cbranch_scc1 L_wdone_17
  s_sub_u32 s13, s13, 1
  s_cmp_lg_u32 s13, 0
  s_cbranch_scc1 L_wspin_16
L_wdone_17:
  ds_read_b64_tr_b16 v[40:41], v20 offset:40960
  ds_read_b64_tr_b16 v[42:43], v20 offset:49152
  ds_read_b64_tr_b16 v[44:45], v21 offset:40960
  ds_read_b64_tr_b16 v[46:47], v21 offset:49152
  ds_read_b64_tr_b16 v[48:49], v22 offset:40960
  ds_read_b64_tr_b16 v[50:51], v22 offset:49152
  ds_read_b64_tr_b16 v[52:53], v23 offset:40960
  ds_read_b64_tr_b16 v[54:55], v23 offset:49152
  s_waitcnt lgkmcnt(0)
  s_barrier
  s_mov_b64 exec, s[16:17]
  ds_read_b128 v[72:75], v24 offset:6912
  s_mov_b64 exec, s[18:19]
  ds_read_b128 v[76:79], v24 offset:6912
  s_mov_b64 exec, s[20:21]
  ds_read_b128 v[80:83], v24 offset:6912
  s_mov_b64 exec, s[22:23]
  ds_read_b128 v[84:87], v24 offset:6912
  s_mov_b64 exec, -1
  s_waitcnt lgkmcnt(3)
  s_nop 0
  v_mfma_f32_16x16x32_bf16 v[100:103], v[72:75], v[40:43], 0
  s_waitcnt lgkmcnt(2)
  v_mfma_f32_16x16x32_bf16 v[100:103], v[76:79], v[44:47], v[100:103]
  s_waitcnt lgkmcnt(1)
  v_mfma_f32_16x16x32_bf16 v[100:103], v[80:83], v[48:51], v[100:103]
  s_waitcnt lgkmcnt(0)
  v_mfma_f32_16x16x32_bf16 v[100:103], v[84:87], v[52:55], v[100:103]
  s_nop 7
  v_pk_fma_f32 v[100:101], v[100:101], v[92:93], v[88:89]
  v_pk_fma_f32 v[102:103], v[102:103], v[94:95], v[90:91]
  v_add_u32 v100, 0x200, v100
  v_add_u32 v101, 0x200, v101
  v_add_u32 v102, 0x200, v102
  v_add_u32 v103, 0x200, v103
  v_bfi_b32 v100, v39, s72, v100
  v_bfi_b32 v101, v39, s73, v101
  v_bfi_b32 v102, v39, s74, v102
  v_bfi_b32 v103, v39, s75, v103
  buffer_store_dwordx4 v[100:103], v26, s[52:55], s56 offen sc1
  s_barrier
  s_endpgm
L_gath_5:
  s_waitcnt lgkmcnt(0)
  s_barrier
  buffer_load_dwordx4 v[88:91], v4, s[52:55], s56 offen sc1
  s_mov_b32 s13, 20000
  s_nop 1
  buffer_load_dwordx4 v[72:75], v5, s[52:55], s57 offen sc1
  s_sleep 1
  buffer_load_dwordx4 v[76:79], v5, s[52:55], s57 offen sc1
L_pp_18:
  s_waitcnt vmcnt(1)
  v_xor_b32 v12, s72, v72
  v_xor_b32 v13, s73, v73
  v_xor_b32 v14, s74, v74
  v_xor_b32 v15, s75, v75
  v_or3_b32 v16, v12, v13, v14
  v_or_b32 v16, v16, v15
  v_and_b32 v16, 0x3ff, v16
  v_cmp_ne_u32 vcc, 0, v16
  s_nop 1
  s_and_b64 exec, exec, vcc
  s_cbranch_execz L_ppd_19
  buffer_load_dwordx4 v[72:75], v5, s[52:55], s57 offen sc1
  s_waitcnt vmcnt(1)
  v_xor_b32 v12, s72, v76
  v_xor_b32 v13, s73, v77
  v_xor_b32 v14, s74, v78
  v_xor_b32 v15, s75, v79
  v_or3_b32 v16, v12, v13, v14
  v_or_b32 v16, v16, v15
  v_and_b32 v16, 0x3ff, v16
  v_cmp_ne_u32 vcc, 0, v16
  s_nop 1
  s_and_b64 exec, exec, vcc
  s_cbranch_execz L_ppd_19
  buffer_load_dwordx4 v[76:79], v5, s[52:55], s57 offen sc1
  s_sub_u32 s13, s13, 1
  s_cmp_lg_u32 s13, 0
  s_cbranch_scc1 L_pp_18
L_ppd_19:
  s_mov_b64 exec, -1
  buffer_load_dwordx4 v[80:83], v4, s[52:55], s56 offen sc1
  v_add_f32 v12, v12, v13
  v_add_f32 v14, v14, v15
  v_mov_b32 v20, v12
  s_nop 1
  v_max_f32_dpp v20, v20, v20 row_ror:8 row_mask:0xf bank_mask:0xf
  v_mov_b32 v21, v20
  s_nop 1
  v_permlane16_swap_b32 v20, v21
  v_max_f32 v20, v20, v21
  v_mov_b32 v21, v20
  s_nop 1
  v_permlane32_swap_b32 v20, v21
  v_max_f32 v20, v20, v21
  v_sub_f32 v18, v12, v20
  v_exp_f32 v18, v18
  buffer_load_dwordx4 v[84:87], v4, s[52:55], s56 offen sc1
  v_mul_f32 v14, v14, v18
  s_nop 1
  v_add_f32_dpp v14, v14, v14 row_ror:8 row_mask:0xf bank_mask:0xf
  v_mov_b32 v21, v14
  s_nop 1
  v_permlane16_swap_b32 v14, v21
  v_add_f32 v14, v14, v21
  v_mov_b32 v21, v14
  s_nop 1
  v_permlane32_swap_b32 v14, v21
  v_add_f32 v14, v14, v21
  v_rcp_f32 v14, v14
  s_nop 0
  v_mul_f32 v18, v18, v14
  s_mov_b32 s13, 20000
  s_nop 1
L_pp_20:
  s_waitcnt vmcnt(1)
  v_xor_b32 v8, s72, v80
  v_xor_b32 v9, s73, v81
  v_xor_b32 v10, s74, v82
  v_xor_b32 v11, s75, v83
  v_or3_b32 v16, v8, v9, v10
  v_or_b32 v16, v16, v11
  v_and_b32 v16, 0x3ff, v16
  v_cmp_ne_u32 vcc, 0, v16
  s_nop 1
  s_and_b64 exec, exec, vcc
  s_cbranch_execz L_ppd_21
  s_sleep 1
  buffer_load_dwordx4 v[80:83], v4, s[52:55], s56 offen sc1
  s_waitcnt vmcnt(1)
  v_xor_b32 v8, s72, v84
  v_xor_b32 v9, s73, v85
  v_xor_b32 v10, s74, v86
  v_xor_b32 v11, s75, v87
  v_or3_b32 v16, v8, v9, v10
  v_or_b32 v16, v16, v11
  v_and_b32 v16, 0x3ff, v16
  v_cmp_ne_u32 vcc, 0, v16
  s_nop 1
  s_and_b64 exec, exec, vcc
  s_cbranch_execz L_ppd_21
  s_sleep 1
  buffer_load_dwordx4 v[84:87], v4, s[52:55], s56 offen sc1
  s_sub_u32 s13, s13, 1
  s_cmp_lg_u32 s13, 0
  s_cbranch_scc1 L_pp_20
L_ppd_21:
  s_mov_b64 exec, -1
  v_pk_mul_f32 v[8:9], v[8:9], v[18:19] op_sel_hi:[1,0]
  v_pk_mul_f32 v[10:11], v[10:11], v[18:19] op_sel_hi:[1,0]
  s_nop 0
  v_permlane16_swap_b32 v8, v9
  v_permlane16_swap_b32 v10, v11
  v_add_f32 v8, v8, v9
  v_add_f32 v10, v10, v11
  s_nop 1
  v_permlane32_swap_b32 v8, v10
  v_add_f32 v8, v8, v10
  s_nop 1
  v_add_f32_dpp v8, v8, v8 row_ror:8 row_mask:0xf bank_mask:0xf
  v_cvt_pk_bf16_f32 v8, v8, v8
  s_mov_b32 exec_lo, 0x00ff00ff
  s_mov_b32 exec_hi, exec_lo
  ds_write_b16 v6, v8
  s_mov_b64 exec, -1
  s_waitcnt lgkmcnt(0)
  s_barrier
  s_barrier
  s_endpgm
L_helper2:
  s_mov_b32 s56, s34
  s_mov_b32 s57, s35
  s_mov_b32 s58, 0x400
  s_mov_b32 s59, 0x00020000
  s_mov_b32 m0, 0x1100
  s_nop 0
  buffer_load_dwordx4 v4, s[56:59], 0 offen lds
  s_mov_b32 s27, s3
  s_mov_b32 s90, s4
  s_cmp_eq_u32 s3, 5
  s_cselect_b32 s9, 14, 28
  s_cmp_eq_u32 s3, 7
  s_cselect_b32 s9, 22, s9
  s_cmp_lt_u32 s4, s9
  s_cselect_b32 s26, 1, 0
  s_cmp_lt_u32 s4, 28
  s_cbranch_scc1 L_fmp_23
  s_lshl_b32 s9, s3, 2
  s_lshr_b32 s9, 0x3040251, s9
  s_and_b32 s26, s9, 7
  s_lshl_b32 s9, s26, 2
  s_add_u32 s90, s9, s4
  s_sub_u32 s90, s90, 32
  s_cmp_lt_u32 s90, 14
  s_cselect_b32 s27, 5, 7
  s_cselect_b32 s9, 14, 8
  s_add_u32 s90, s90, s9
L_fmp_23:
  s_cmp_eq_u32 s26, 0
  s_cbranch_scc1 L_noffn_24
  s_cmp_ge_u32 s27, 4
  s_cselect_b32 s60, s30, s28
  s_cselect_b32 s61, s31, s29
  s_mov_b32 s62, 0x1c0000
  s_mov_b32 s63, 0x00020000
  s_and_b32 s9, s27, 3
  s_mul_i32 s9, s9, 458752
  s_lshl_b32 s10, s90, 7
  s_add_u32 s14, s9, s10
  s_mov_b32 m0, 0x6000
  s_nop 0
  buffer_load_dwordx4 v8, s[60:63], s14 offen nt lds
  s_mov_b32 m0, 0x6400
  s_add_u32 s14, s14, 0x7000
  buffer_load_dwordx4 v8, s[60:63], s14 offen nt lds
  s_mov_b32 m0, 0x6800
  s_add_u32 s14, s14, 0x7000
  buffer_load_dwordx4 v8, s[60:63], s14 offen nt lds
  s_mov_b32 m0, 0x6c00
  s_add_u32 s14, s14, 0x7000
  buffer_load_dwordx4 v8, s[60:63], s14 offen nt lds
  s_mov_b32 m0, 0x7000
  s_add_u32 s14, s14, 0x7000
  buffer_load_dwordx4 v8, s[60:63], s14 offen nt lds
  s_mov_b32 m0, 0x7400
  s_add_u32 s14, s14, 0x7000
  buffer_load_dwordx4 v8, s[60:63], s14 offen nt lds
  s_mov_b32 m0, 0x7800
  s_add_u32 s14, s14, 0x7000
  buffer_load_dwordx4 v8, s[60:63], s14 offen nt lds
  s_mov_b32 m0, 0x7c00
  s_add_u32 s14, s14, 0x7000
  buffer_load_dwordx4 v8, s[60:63], s14 offen nt lds
  s_mov_b32 m0, 0x8000
  s_add_u32 s14, s14, 0x7000
  buffer_load_dwordx4 v8, s[60:63], s14 offen nt lds
  s_mov_b32 m0, 0x8400
  s_add_u32 s14, s14, 0x7000
  buffer_load_dwordx4 v8, s[60:63], s14 offen nt lds
  s_mov_b32 m0, 0x8800
  s_add_u32 s14, s14, 0x7000
  buffer_load_dwordx4 v8, s[60:63], s14 offen nt lds
  s_mov_b32 m0, 0x8c00
  s_add_u32 s14, s14, 0x7000
  buffer_load_dwordx4 v8, s[60:63], s14 offen nt lds
  s_mov_b32 m0, 0x9000
  s_add_u32 s14, s14, 0x7000
  buffer_load_dwordx4 v8, s[60:63], s14 offen nt lds
  s_mov_b32 m0, 0x9400
  s_add_u32 s14, s14, 0x7000
  buffer_load_dwordx4 v8, s[60:63], s14 offen nt lds
  s_mov_b32 m0, 0x9800
  s_add_u32 s14, s14, 0x7000
  buffer_load_dwordx4 v8, s[60:63], s14 offen nt lds
  s_mov_b32 m0, 0x9c00
  s_add_u32 s14, s14, 0x7000
  buffer_load_dwordx4 v8, s[60:63], s14 offen nt lds
L_noffn_24:
  v_and_b32 v9, 3, v0
  v_mul_u32_u24 v9, 1056, v9
  v_lshrrev_b32 v10, 4, v0
  v_lshlrev_b32 v10, 3, v10
  v_add_u32 v9, v9, v10
  s_and_b32 s9, s4, 3
  s_lshl_b32 s9, s9, 8
  v_add_u32 v10, s9, v9
  s_and_b32 s9, s27, 3
  s_lshl_b32 s9, s9, 8
  v_add_u32 v12, s9, v9
  v_lshrrev_b32 v13, 2, v0
  v_and_b32 v14, 6, v13
  v_lshlrev_b32 v13, 7, v13
  v_bfe_u32 v15, v0, 1, 1
  v_add_u32 v14, v14, v15
  v_lshlrev_b32 v14, 4, v14
  v_add_u32 v13, v13, v14
  v_and_b32 v14, 1, v0
  v_lshlrev_b32 v14, 3, v14
  v_add_u32 v32, v13, v14
  v_xor_b32 v33, 32, v32
  v_xor_b32 v34, 64, v32
  v_xor_b32 v35, 96, v32
  v_mov_b32 v39, 0x3ff
  s_mov_b32 s68, 0xf0f0f0f0
  s_mov_b32 s69, 0xf0f0f0f0
  s_mov_b32 s76, 0xff00ff00
  s_mov_b32 s77, 0xff00ff00
  v_and_b32 v13, 3, v0
  v_bfe_u32 v14, v0, 2, 2
  v_lshrrev_b32 v15, 4, v0
  v_lshlrev_b32 v15, 4, v15
  v_lshlrev_b32 v36, 13, v13
  v_lshlrev_b32 v37, 6, v14
  v_add3_u32 v36, v36, v37, v15
  v_lshlrev_b32 v37, 11, v14
  v_lshlrev_b32 v38, 6, v13
  v_add3_u32 v37, v37, v38, v15
  s_lshl_b32 s10, s3, 15
  s_and_b32 s11, s4, 3
  s_lshl_b32 s11, s11, 11
  s_add_u32 s10, s10, s11
  s_lshr_b32 s11, s4, 2
  s_lshl_b32 s11, s11, 8
  s_add_u32 s10, s10, s11
  s_add_u32 s11, s10, 0x10000
  s_cmp_lg_u32 s26, 0
  s_cbranch_scc1 L_wa_25
  s_waitcnt vmcnt(1)
  s_branch L_wb_26
L_wa_25:
  s_waitcnt vmcnt(17)
L_wb_26:
  v_readfirstlane_b32 s8, v2
  s_nop 0
  s_add_u32 s8, s8, 0x9e3779b9
  ds_read2_b64 a[0:3], v10 offset0:0 offset1:4
  ds_read2_b64 a[4:7], v10 offset0:8 offset1:12
  ds_read2_b64 a[8:11], v10 offset0:16 offset1:20
  ds_read2_b64 a[12:15], v10 offset0:24 offset1:28
  ds_read2_b64 a[16:19], v12 offset0:0 offset1:4
  ds_read2_b64 a[20:23], v12 offset0:8 offset1:12
  ds_read2_b64 a[24:27], v12 offset0:16 offset1:20
  ds_read2_b64 a[28:31], v12 offset0:24 offset1:28
  v_mov_b32 v11, s8
  ds_write_b32 v1, v11 offset:4
  s_mul_i32 s15, s8, 0x85ebca6b
  s_bfe_u32 s72, s8, 0x80000
  s_bfe_u32 s9, s15, 0x20018
  s_lshl_b32 s9, s9, 8
  s_or_b32 s72, s72, s9
  s_bfe_u32 s73, s8, 0x80008
  s_bfe_u32 s9, s15, 0x2001a
  s_lshl_b32 s9, s9, 8
  s_or_b32 s73, s73, s9
  s_bfe_u32 s74, s8, 0x80010
  s_bfe_u32 s9, s15, 0x2001c
  s_lshl_b32 s9, s9, 8
  s_or_b32 s74, s74, s9
  s_bfe_u32 s75, s8, 0x80018
  s_bfe_u32 s9, s15, 0x2001e
  s_lshl_b32 s9, s9, 8
  s_or_b32 s75, s75, s9
  s_getreg_b32 s71, hwreg(HW_REG_XCC_ID, 0, 4)
  s_xor_b32 s71, s71, s75
  s_waitcnt lgkmcnt(0)
  ds_read_b64_tr_b16 v[40:41], v32 offset:8192
  ds_read_b64_tr_b16 v[42:43], v32 offset:10240
  ds_read_b64_tr_b16 v[44:45], v33 offset:8192
  ds_read_b64_tr_b16 v[46:47], v33 offset:10240
  ds_read_b64_tr_b16 v[48:49], v34 offset:8192
  ds_read_b64_tr_b16 v[50:51], v34 offset:10240
  ds_read_b64_tr_b16 v[52:53], v35 offset:8192
  ds_read_b64_tr_b16 v[54:55], v35 offset:10240
  ds_read_b64_tr_b16 v[56:57], v32 offset:12288
  ds_read_b64_tr_b16 v[58:59], v32 offset:14336
  ds_read_b64_tr_b16 v[60:61], v33 offset:12288
  ds_read_b64_tr_b16 v[62:63], v33 offset:14336
  s_waitcnt lgkmcnt(10)
  v_mfma_f32_16x16x32_bf16 v[16:19], v[40:43], a[0:3], 0
  ds_read_b64_tr_b16 v[64:65], v34 offset:12288
  ds_read_b64_tr_b16 v[66:67], v34 offset:14336
  s_waitcnt lgkmcnt(10)
  v_mfma_f32_16x16x32_bf16 v[20:23], v[44:47], a[0:3], 0
  ds_read_b64_tr_b16 v[68:69], v35 offset:12288
  ds_read_b64_tr_b16 v[70:71], v35 offset:14336
  s_waitcnt lgkmcnt(10)
  v_mfma_f32_16x16x32_bf16 v[24:27], v[48:51], a[0:3], 0
  ds_read_b64_tr_b16 v[72:73], v32 offset:16384
  ds_read_b64_tr_b16 v[74:75], v32 offset:18432
  s_waitcnt lgkmcnt(10)
  v_mfma_f32_16x16x32_bf16 v[28:31], v[52:55], a[0:3], 0
  ds_read_b64_tr_b16 v[76:77], v33 offset:16384
  ds_read_b64_tr_b16 v[78:79], v33 offset:18432
  s_waitcnt lgkmcnt(10)
  v_mfma_f32_16x16x32_bf16 v[16:19], v[56:59], a[4:7], v[16:19]
  ds_read_b64_tr_b16 v[80:81], v34 offset:16384
  ds_read_b64_tr_b16 v[82:83], v34 offset:18432
  s_waitcnt lgkmcnt(10)
  v_mfma_f32_16x16x32_bf16 v[20:23], v[60:63], a[4:7], v[20:23]
  ds_read_b64_tr_b16 v[84:85], v35 offset:16384
  ds_read_b64_tr_b16 v[86:87], v35 offset:18432
  s_waitcnt lgkmcnt(10)
  v_mfma_f32_16x16x32_bf16 v[24:27], v[64:67], a[4:7], v[24:27]
  ds_read_b64_tr_b16 v[88:89], v32 offset:20480
  ds_read_b64_tr_b16 v[90:91], v32 offset:22528
  s_waitcnt lgkmcnt(10)
  v_mfma_f32_16x16x32_bf16 v[28:31], v[68:71], a[4:7], v[28:31]
  ds_read_b64_tr_b16 v[92:93], v33 offset:20480
  ds_read_b64_tr_b16 v[94:95], v33 offset:22528
  s_waitcnt lgkmcnt(10)
  v_mfma_f32_16x16x32_bf16 v[16:19], v[72:75], a[8:11], v[16:19]
  ds_read_b64_tr_b16 v[96:97], v34 offset:20480
  ds_read_b64_tr_b16 v[98:99], v34 offset:22528
  s_waitcnt lgkmcnt(10)
  v_mfma_f32_16x16x32_bf16 v[20:23], v[76:79], a[8:11], v[20:23]
  ds_read_b64_tr_b16 v[100:101], v35 offset:20480
  ds_read_b64_tr_b16 v[102:103], v35 offset:22528
  s_waitcnt lgkmcnt(10)
  v_mfma_f32_16x16x32_bf16 v[24:27], v[80:83], a[8:11], v[24:27]
  s_waitcnt lgkmcnt(8)
  v_mfma_f32_16x16x32_bf16 v[28:31], v[84:87], a[8:11], v[28:31]
  s_waitcnt lgkmcnt(6)
  v_mfma_f32_16x16x32_bf16 v[16:19], v[88:91], a[12:15], v[16:19]
  s_waitcnt lgkmcnt(4)
  v_mfma_f32_16x16x32_bf16 v[20:23], v[92:95], a[12:15], v[20:23]
  s_waitcnt lgkmcnt(2)
  v_mfma_f32_16x16x32_bf16 v[24:27], v[96:99], a[12:15], v[24:27]
  s_waitcnt lgkmcnt(0)
  v_mfma_f32_16x16x32_bf16 v[28:31], v[100:103], a[12:15], v[28:31]
  s_nop 3
  v_cndmask_b32 v16, v16, v20, s[68:69]
  v_cndmask_b32 v17, v17, v21, s[68:69]
  v_cndmask_b32 v18, v18, v22, s[68:69]
  v_cndmask_b32 v19, v19, v23, s[68:69]
  v_cndmask_b32 v24, v24, v28, s[68:69]
  v_cndmask_b32 v25, v25, v29, s[68:69]
  v_cndmask_b32 v26, v26, v30, s[68:69]
  v_cndmask_b32 v27, v27, v31, s[68:69]
  v_cndmask_b32 v16, v16, v24, s[76:77]
  v_cndmask_b32 v17, v17, v25, s[76:77]
  v_cndmask_b32 v18, v18, v26, s[76:77]
  v_cndmask_b32 v19, v19, v27, s[76:77]
  v_add_u32 v16, 0x200, v16
  v_add_u32 v17, 0x200, v17
  v_add_u32 v18, 0x200, v18
  v_add_u32 v19, 0x200, v19
  v_bfi_b32 v16, v39, s72, v16
  v_bfi_b32 v17, v39, s73, v17
  v_bfi_b32 v18, v39, s74, v18
  v_bfi_b32 v19, v39, s71, v19
  buffer_store_dwordx4 v[16:19], v36, s[52:55], s11 offen sc1
  s_lshl_b32 s9, s3, 15
  s_lshl_b32 s10, s5, 13
  s_add_u32 s9, s9, s10
  s_add_u32 s12, s9, 0x10000
  s_add_u32 s14, s12, 4096
  s_cmp_eq_u32 s26, 0
  s_cbranch_scc0 L_hasf_28
  s_sleep 120
  s_branch L_noffn2_27
L_hasf_28:
  s_waitcnt vmcnt(1)
  ds_read_b64_tr_b16 v[40:41], v32 offset:24576
  ds_read_b64_tr_b16 v[42:43], v32 offset:26624
  ds_read_b64_tr_b16 v[44:45], v33 offset:24576
  ds_read_b64_tr_b16 v[46:47], v33 offset:26624
  ds_read_b64_tr_b16 v[48:49], v34 offset:24576
  ds_read_b64_tr_b16 v[50:51], v34 offset:26624
  ds_read_b64_tr_b16 v[52:53], v35 offset:24576
  ds_read_b64_tr_b16 v[54:55], v35 offset:26624
  ds_read_b64_tr_b16 v[56:57], v32 offset:28672
  ds_read_b64_tr_b16 v[58:59], v32 offset:30720
  ds_read_b64_tr_b16 v[60:61], v33 offset:28672
  ds_read_b64_tr_b16 v[62:63], v33 offset:30720
  s_waitcnt lgkmcnt(10)
  v_mfma_f32_16x16x32_bf16 v[16:19], v[40:43], a[16:19], 0
  ds_read_b64_tr_b16 v[64:65], v34 offset:28672
  ds_read_b64_tr_b16 v[66:67], v34 offset:30720
  s_waitcnt lgkmcnt(10)
  v_mfma_f32_16x16x32_bf16 v[20:23], v[44:47], a[16:19], 0
  ds_read_b64_tr_b16 v[68:69], v35 offset:28672
  ds_read_b64_tr_b16 v[70:71], v35 offset:30720
  s_waitcnt lgkmcnt(10)
  v_mfma_f32_16x16x32_bf16 v[24:27], v[48:51], a[16:19], 0
  ds_read_b64_tr_b16 v[72:73], v32 offset:32768
  ds_read_b64_tr_b16 v[74:75], v32 offset:34816
  s_waitcnt lgkmcnt(10)
  v_mfma_f32_16x16x32_bf16 v[28:31], v[52:55], a[16:19], 0
  ds_read_b64_tr_b16 v[76:77], v33 offset:32768
  ds_read_b64_tr_b16 v[78:79], v33 offset:34816
  s_waitcnt lgkmcnt(10)
  v_mfma_f32_16x16x32_bf16 v[16:19], v[56:59], a[20:23], v[16:19]
  ds_read_b64_tr_b16 v[80:81], v34 offset:32768
  ds_read_b64_tr_b16 v[82:83], v34 offset:34816
  s_waitcnt lgkmcnt(10)
  v_mfma_f32_16x16x32_bf16 v[20:23], v[60:63], a[20:23], v[20:23]
  ds_read_b64_tr_b16 v[84:85], v35 offset:32768
  ds_read_b64_tr_b16 v[86:87], v35 offset:34816
  s_waitcnt lgkmcnt(10)
  v_mfma_f32_16x16x32_bf16 v[24:27], v[64:67], a[20:23], v[24:27]
  ds_read_b64_tr_b16 v[88:89], v32 offset:36864
  ds_read_b64_tr_b16 v[90:91], v32 offset:38912
  s_waitcnt lgkmcnt(10)
  v_mfma_f32_16x16x32_bf16 v[28:31], v[68:71], a[20:23], v[28:31]
  ds_read_b64_tr_b16 v[92:93], v33 offset:36864
  ds_read_b64_tr_b16 v[94:95], v33 offset:38912
  s_waitcnt lgkmcnt(10)
  v_mfma_f32_16x16x32_bf16 v[16:19], v[72:75], a[24:27], v[16:19]
  ds_read_b64_tr_b16 v[96:97], v34 offset:36864
  ds_read_b64_tr_b16 v[98:99], v34 offset:38912
  s_waitcnt lgkmcnt(10)
  v_mfma_f32_16x16x32_bf16 v[20:23], v[76:79], a[24:27], v[20:23]
  ds_read_b64_tr_b16 v[100:101], v35 offset:36864
  ds_read_b64_tr_b16 v[102:103], v35 offset:38912
  s_waitcnt lgkmcnt(10)
  v_mfma_f32_16x16x32_bf16 v[24:27], v[80:83], a[24:27], v[24:27]
  s_waitcnt lgkmcnt(8)
  v_mfma_f32_16x16x32_bf16 v[28:31], v[84:87], a[24:27], v[28:31]
  s_waitcnt lgkmcnt(6)
  v_mfma_f32_16x16x32_bf16 v[16:19], v[88:91], a[28:31], v[16:19]
  s_waitcnt lgkmcnt(4)
  v_mfma_f32_16x16x32_bf16 v[20:23], v[92:95], a[28:31], v[20:23]
  s_waitcnt lgkmcnt(2)
  v_mfma_f32_16x16x32_bf16 v[24:27], v[96:99], a[28:31], v[24:27]
  s_waitcnt lgkmcnt(0)
  v_mfma_f32_16x16x32_bf16 v[28:31], v[100:103], a[28:31], v[28:31]
  s_lshl_b32 s9, s90, 13
  s_lshr_b32 s10, s27, 2
  s_lshl_b32 s10, s10, 10
  s_add_u32 s9, s9, s10
  s_and_b32 s10, s27, 3
  s_lshl_b32 s10, s10, 8
  s_add_u32 s9, s9, s10
  s_add_u32 s11, s9, 0x50000
  v_cndmask_b32 v16, v16, v20, s[68:69]
  v_cndmask_b32 v17, v17, v21, s[68:69]
  v_cndmask_b32 v18, v18, v22, s[68:69]
  v_cndmask_b32 v19, v19, v23, s[68:69]
  v_cndmask_b32 v24, v24, v28, s[68:69]
  v_cndmask_b32 v25, v25, v29, s[68:69]
  v_cndmask_b32 v26, v26, v30, s[68:69]
  v_cndmask_b32 v27, v27, v31, s[68:69]
  v_cndmask_b32 v16, v16, v24, s[76:77]
  v_cndmask_b32 v17, v17, v25, s[76:77]
  v_cndmask_b32 v18, v18, v26, s[76:77]
  v_cndmask_b32 v19, v19, v27, s[76:77]
  v_add_u32 v16, 0x200, v16
  v_add_u32 v17, 0x200, v17
  v_add_u32 v18, 0x200, v18
  v_add_u32 v19, 0x200, v19
  v_bfi_b32 v16, v39, s72, v16
  v_bfi_b32 v17, v39, s73, v17
  v_bfi_b32 v18, v39, s74, v18
  v_bfi_b32 v19, v39, s75, v19
  buffer_store_dwordx4 v[16:19], v37, s[52:55], s11 offen sc1
L_noffn2_27:
  s_nop 7
  s_mov_b32 s13, 20000
L_poll_29:
  s_nop 1
  buffer_load_dwordx4 a[32:35], v4, s[52:55], s12 offen offset:0 sc1
  buffer_load_dwordx4 a[36:39], v4, s[52:55], s12 offen offset:1024 sc1
  buffer_load_dwordx4 a[40:43], v4, s[52:55], s12 offen offset:2048 sc1
  buffer_load_dwordx4 a[44:47], v4, s[52:55], s12 offen offset:3072 sc1
  buffer_load_dwordx4 a[48:51], v4, s[52:55], s14 offen offset:0 sc1
  buffer_load_dwordx4 a[52:55], v4, s[52:55], s14 offen offset:1024 sc1
  buffer_load_dwordx4 a[56:59], v4, s[52:55], s14 offen offset:2048 sc1
  buffer_load_dwordx4 a[60:63], v4, s[52:55], s14 offen offset:3072 sc1
  s_waitcnt vmcnt(0)
  v_accvgpr_read_b32 v40, a32
  v_accvgpr_read_b32 v41, a33
  v_accvgpr_read_b32 v42, a34
  v_accvgpr_read_b32 v43, a35
  v_accvgpr_read_b32 v44, a36
  v_accvgpr_read_b32 v45, a37
  v_accvgpr_read_b32 v46, a38
  v_accvgpr_read_b32 v47, a39
  v_accvgpr_read_b32 v48, a40
  v_accvgpr_read_b32 v49, a41
  v_accvgpr_read_b32 v50, a42
  v_accvgpr_read_b32 v51, a43
  v_accvgpr_read_b32 v52, a44
  v_accvgpr_read_b32 v53, a45
  v_accvgpr_read_b32 v54, a46
  v_accvgpr_read_b32 v55, a47
  v_accvgpr_read_b32 v56, a48
  v_accvgpr_read_b32 v57, a49
  v_accvgpr_read_b32 v58, a50
  v_accvgpr_read_b32 v59, a51
  v_accvgpr_read_b32 v60, a52
  v_accvgpr_read_b32 v61, a53
  v_accvgpr_read_b32 v62, a54
  v_accvgpr_read_b32 v63, a55
  v_accvgpr_read_b32 v64, a56
  v_accvgpr_read_b32 v65, a57
  v_accvgpr_read_b32 v66, a58
  v_accvgpr_read_b32 v67, a59
  v_accvgpr_read_b32 v68, a60
  v_accvgpr_read_b32 v69, a61
  v_accvgpr_read_b32 v70, a62
  v_accvgpr_read_b32 v71, a63
  v_xor_b32 v40, s72, v40
  v_xor_b32 v41, s73, v41
  v_xor_b32 v42, s74, v42
  v_xor_b32 v43, s71, v43
  v_xor_b32 v44, s72, v44
  v_xor_b32 v45, s73, v45
  v_xor_b32 v46, s74, v46
  v_xor_b32 v47, s71, v47
  v_xor_b32 v48, s72, v48
  v_xor_b32 v49, s73, v49
  v_xor_b32 v50, s74, v50
  v_xor_b32 v51, s71, v51
  v_xor_b32 v52, s72, v52
  v_xor_b32 v53, s73, v53
  v_xor_b32 v54, s74, v54
  v_xor_b32 v55, s71, v55
  v_xor_b32 v56, s72, v56
  v_xor_b32 v57, s73, v57
  v_xor_b32 v58, s74, v58
  v_xor_b32 v59, s71, v59
  v_xor_b32 v60, s72, v60
  v_xor_b32 v61, s73, v61
  v_xor_b32 v62, s74, v62
  v_xor_b32 v63, s71, v63
  v_xor_b32 v64, s72, v64
  v_xor_b32 v65, s73, v65
  v_xor_b32 v66, s74, v66
  v_xor_b32 v67, s71, v67
  v_xor_b32 v68, s72, v68
  v_xor_b32 v69, s73, v69
  v_xor_b32 v70, s74, v70
  v_xor_b32 v71, s71, v71
  v_or3_b32 v16, v40, v41, v42
  v_or3_b32 v17, v43, v47, v51
  v_or3_b32 v18, v44, v45, v46
  v_or3_b32 v17, v17, v55, v59
  v_or3_b32 v16, v16, v48, v49
  v_or3_b32 v18, v18, v50, v52
  v_or3_b32 v16, v16, v53, v54
  v_or3_b32 v18, v18, v56, v57
  v_or3_b32 v16, v16, v58, v60
  v_or3_b32 v18, v18, v61, v62
  v_or3_b32 v16, v16, v64, v65
  v_or3_b32 v18, v18, v66, v68
  v_or3_b32 v16, v16, v69, v70
  v_or3_b32 v17, v17, v63, v67
  v_or_b32 v17, v17, v71
  v_or_b32 v16, v16, v18
  v_and_b32 v18, 0x3f0, v17
  v_and_or_b32 v16, v16, v39, v18
  v_cmp_ne_u32 vcc, 0, v16
  s_nop 1
  s_and_b64 exec, exec, vcc
  s_cbranch_execz L_done_30
  s_sleep 1
  s_sub_u32 s13, s13, 1
  s_cmp_lg_u32 s13, 0
  s_cbranch_scc1 L_poll_29
L_done_30:
  s_mov_b64 exec, -1
  v_or3_b32 v17, v43, v47, v51
  v_or3_b32 v17, v17, v55, v59
  v_or3_b32 v17, v17, v63, v67
  v_or_b32 v17, v17, v71
  v_and_b32 v17, 15, v17
  v_cmp_ne_u32 vcc, 0, v17
  v_and_b32 v43, -16, v43
  v_and_b32 v47, -16, v47
  v_and_b32 v51, -16, v51
  v_and_b32 v55, -16, v55
  v_and_b32 v59, -16, v59
  v_and_b32 v63, -16, v63
  v_and_b32 v67, -16, v67
  v_and_b32 v71, -16, v71
  s_cmp_eq_u64 vcc, 0
  s_cselect_b32 s9, 3, 1
  v_mov_b32 v21, s9
  v_add_f32 v40, v40, v48
  v_add_f32 v56, v56, v64
  v_add_f32 v41, v41, v49
  v_add_f32 v57, v57, v65
  v_add_f32 v42, v42, v50
  v_add_f32 v58, v58, v66
  v_add_f32 v43, v43, v51
  v_add_f32 v59, v59, v67
  v_add_f32 v44, v44, v52
  v_add_f32 v60, v60, v68
  v_add_f32 v45, v45, v53
  v_add_f32 v61, v61, v69
  v_add_f32 v46, v46, v54
  v_add_f32 v62, v62, v70
  v_add_f32 v47, v47, v55
  v_add_f32 v63, v63, v71
  v_add_f32 v40, v40, v56
  v_add_f32 v41, v41, v57
  v_add_f32 v42, v42, v58
  v_add_f32 v43, v43, v59
  v_add_f32 v44, v44, v60
  v_add_f32 v45, v45, v61
  v_add_f32 v46, v46, v62
  v_add_f32 v47, v47, v63
  v_cvt_pk_bf16_f32 v40, v40, v41
  v_cvt_pk_bf16_f32 v41, v42, v43
  v_cvt_pk_bf16_f32 v44, v44, v45
  v_cvt_pk_bf16_f32 v45, v46, v47
  v_lshrrev_b32 v16, 5, v0
  v_bfe_u32 v17, v0, 3, 2
  v_and_b32 v18, 7, v0
  v_lshlrev_b32 v18, 3, v18
  v_xor_b32 v19, v17, v16
  v_lshlrev_b32 v19, 6, v19
  v_lshlrev_b32 v20, 8, v16
  v_add3_u32 v19, v19, v20, v18
  v_xor_b32 v20, 0x80, v19
  ds_write_b64 v19, v[40:41] offset:5376
  ds_write_b64 v20, v[44:45] offset:5888
  s_waitcnt lgkmcnt(0)
  ds_write_b32 v1, v21
  v_lshrrev_b32 v10, 4, v0
  v_lshlrev_b32 v10, 3, v10
  v_add_u32 v26, 0x1100, v10
  ds_read2_b64 a[0:3], v9 offset0:0 offset1:4
  ds_read2_b64 a[4:7], v9 offset0:8 offset1:12
  ds_read2_b64 a[8:11], v9 offset0:16 offset1:20
  ds_read2_b64 a[12:15], v9 offset0:24 offset1:28
  ds_read2_b64 a[16:19], v9 offset0:32 offset1:36
  ds_read2_b64 a[20:23], v9 offset0:40 offset1:44
  ds_read2_b64 a[24:27], v9 offset0:48 offset1:52
  ds_read2_b64 a[28:31], v9 offset0:56 offset1:60
  ds_read2_b64 a[32:35], v9 offset0:64 offset1:68
  ds_read2_b64 a[36:39], v9 offset0:72 offset1:76
  ds_read2_b64 a[40:43], v9 offset0:80 offset1:84
  ds_read2_b64 a[44:47], v9 offset0:88 offset1:92
  ds_read2_b64 a[48:51], v9 offset0:96 offset1:100
  ds_read2_b64 a[52:55], v9 offset0:104 offset1:108
  ds_read2_b64 a[56:59], v9 offset0:112 offset1:116
  ds_read2_b64 a[60:63], v9 offset0:120 offset1:124
  ds_read2_b64 v[40:43], v26 offset0:0 offset1:4
  ds_read2_b64 v[44:47], v26 offset0:8 offset1:12
  ds_read2_b64 v[48:51], v26 offset0:16 offset1:20
  ds_read2_b64 v[52:55], v26 offset0:24 offset1:28
  ds_read2_b64 v[56:59], v26 offset0:32 offset1:36
  ds_read2_b64 v[60:63], v26 offset0:40 offset1:44
  ds_read2_b64 v[64:67], v26 offset0:48 offset1:52
  ds_read2_b64 v[68:71], v26 offset0:56 offset1:60
  ds_read2_b64 v[72:75], v26 offset0:64 offset1:68
  ds_read2_b64 v[76:79], v26 offset0:72 offset1:76
  ds_read2_b64 v[80:83], v26 offset0:80 offset1:84
  ds_read2_b64 v[84:87], v26 offset0:88 offset1:92
  ds_read2_b64 v[88:91], v26 offset0:96 offset1:100
  ds_read2_b64 v[92:95], v26 offset0:104 offset1:108
  ds_read2_b64 v[96:99], v26 offset0:112 offset1:116
  ds_read2_b64 v[100:103], v26 offset0:120 offset1:124
  s_waitcnt lgkmcnt(0)
  v_mfma_f32_16x16x32_bf16 v[16:19], v[40:43], a[0:3], 0
  v_mfma_f32_16x16x32_bf16 v[20:23], v[44:47], a[4:7], 0
  v_mfma_f32_16x16x32_bf16 v[16:19], v[48:51], a[8:11], v[16:19]
  v_mfma_f32_16x16x32_bf16 v[20:23], v[52:55], a[12:15], v[20:23]
  v_mfma_f32_16x16x32_bf16 v[16:19], v[56:59], a[16:19], v[16:19]
  v_mfma_f32_16x16x32_bf16 v[20:23], v[60:63], a[20:23], v[20:23]
  v_mfma_f32_16x16x32_bf16 v[16:19], v[64:67], a[24:27], v[16:19]
  v_mfma_f32_16x16x32_bf16 v[20:23], v[68:71], a[28:31], v[20:23]
  v_mfma_f32_16x16x32_bf16 v[16:19], v[72:75], a[32:35], v[16:19]
  v_mfma_f32_16x16x32_bf16 v[20:23], v[76:79], a[36:39], v[20:23]
  v_mfma_f32_16x16x32_bf16 v[16:19], v[80:83], a[40:43], v[16:19]
  v_mfma_f32_16x16x32_bf16 v[20:23], v[84:87], a[44:47], v[20:23]
  v_mfma_f32_16x16x32_bf16 v[16:19], v[88:91], a[48:51], v[16:19]
  v_mfma_f32_16x16x32_bf16 v[20:23], v[92:95], a[52:55], v[20:23]
  v_mfma_f32_16x16x32_bf16 v[16:19], v[96:99], a[56:59], v[16:19]
  v_mfma_f32_16x16x32_bf16 v[20:23], v[100:103], a[60:63], v[20:23]
  s_nop 7
  v_add_f32 v16, v16, v20
  v_cvt_pk_bf16_f32 v16, v16, v16
  v_lshlrev_b32 v16, 16, v16
  v_mul_f32 v17, 0xbfb8aa3b, v16
  v_exp_f32 v17, v17
  s_nop 0
  v_add_f32 v17, 1.0, v17
  v_rcp_f32 v17, v17
  s_nop 0
  v_cvt_pk_bf16_f32 v17, v17, v17
  v_lshlrev_b32 v17, 16, v17
  v_sub_f32 v18, 1.0, v17
  v_cvt_pk_bf16_f32 v18, v18, v18
  v_lshlrev_b32 v18, 16, v18
  v_lshlrev_b32 v19, 2, v0
  s_mov_b64 exec, 0xf
  ds_write_b32 v19, v17 offset:6416
  ds_write_b32 v19, v18 offset:6432
  s_mov_b64 exec, -1
  s_lshl_b32 s96, s3, 8
  s_add_u32 s96, s96, 0x98000
  s_mov_b32 s97, 0
  v_and_b32 v57, 31, v0
  v_lshlrev_b32 v57, 2, v57
  s_bitcmp1_b32 s3, 0
  s_cselect_b64 s[92:93], 0, -1
  s_cmp_ge_u32 s42, 14
  s_cbranch_scc1 L_noh_31
  s_lshl_b32 s9, s43, 11
  s_add_u32 s12, s9, 0x50000
  s_mov_b32 s13, 20000
L_poll_32:
  s_nop 1
  buffer_load_dwordx4 v[40:43], v4, s[52:55], s12 offen sc1
  buffer_load_dwordx4 v[44:47], v4, s[52:55], s12 offen offset:1024 sc1
  s_waitcnt vmcnt(0)
  v_xor_b32 v40, s72, v40
  v_xor_b32 v41, s73, v41
  v_xor_b32 v42, s74, v42
  v_xor_b32 v43, s75, v43
  v_xor_b32 v44, s72, v44
  v_xor_b32 v45, s73, v45
  v_xor_b32 v46, s74, v46
  v_xor_b32 v47, s75, v47
  v_or3_b32 v16, v40, v41, v42
  v_or_b32 v16, v16, v43
  v_or3_b32 v17, v44, v45, v46
  v_or_b32 v17, v17, v47
  v_or_b32 v16, v16, v17
  v_and_b32 v16, 0x3ff, v16
  v_cmp_ne_u32 vcc, 0, v16
  s_nop 1
  s_and_b64 exec, exec, vcc
  s_cbranch_execz L_done_33
  s_sleep 1
  s_sub_u32 s13, s13, 1
  s_cmp_lg_u32 s13, 0
  s_cbranch_scc1 L_poll_32
L_done_33:
  s_mov_b64 exec, -1
  v_mov_b32 v48, v40
  v_mov_b32 v49, v41
  v_mov_b32 v50, v42
  v_mov_b32 v51, v43
  v_mov_b32 v52, v44
  v_mov_b32 v53, v45
  v_mov_b32 v54, v46
  v_mov_b32 v55, v47
  v_permlane16_swap_b32 v40, v48
  v_permlane16_swap_b32 v41, v49
  v_permlane16_swap_b32 v42, v50
  v_permlane16_swap_b32 v43, v51
  v_permlane16_swap_b32 v44, v52
  v_permlane16_swap_b32 v45, v53
  v_permlane16_swap_b32 v46, v54
  v_permlane16_swap_b32 v47, v55
  v_add_f32 v40, v40, v48
  v_add_f32 v41, v41, v49
  v_add_f32 v42, v42, v50
  v_add_f32 v43, v43, v51
  v_add_f32 v44, v44, v52
  v_add_f32 v45, v45, v53
  v_add_f32 v46, v46, v54
  v_add_f32 v47, v47, v55
  v_mov_b32 v48, v40
  v_mov_b32 v49, v41
  v_mov_b32 v50, v42
  v_mov_b32 v51, v43
  v_mov_b32 v52, v44
  v_mov_b32 v53, v45
  v_mov_b32 v54, v46
  v_mov_b32 v55, v47
  v_permlane32_swap_b32 v40, v48
  v_permlane32_swap_b32 v41, v49
  v_permlane32_swap_b32 v42, v50
  v_permlane32_swap_b32 v43, v51
  v_permlane32_swap_b32 v44, v52
  v_permlane32_swap_b32 v45, v53
  v_permlane32_swap_b32 v46, v54
  v_permlane32_swap_b32 v47, v55
  v_add_f32 v40, v40, v48
  v_add_f32 v41, v41, v49
  v_add_f32 v42, v42, v50
  v_add_f32 v43, v43, v51
  v_add_f32 v44, v44, v52
  v_add_f32 v45, v45, v53
  v_add_f32 v46, v46, v54
  v_add_f32 v47, v47, v55
  s_mov_b32 s9, 0xffff0000
  v_cvt_pk_bf16_f32 v40, v40, v41
  v_cvt_pk_bf16_f32 v42, v42, v43
  v_cvt_pk_bf16_f32 v44, v44, v45
  v_cvt_pk_bf16_f32 v46, v46, v47
  v_and_b32 v41, s9, v40
  v_lshlrev_b32 v40, 16, v40
  v_and_b32 v43, s9, v42
  v_lshlrev_b32 v42, 16, v42
  v_and_b32 v45, s9, v44
  v_lshlrev_b32 v44, 16, v44
  v_and_b32 v47, s9, v46
  v_lshlrev_b32 v46, 16, v46
  v_mul_f32 v48, 0xbfb8aa3b, v40
  v_mul_f32 v49, 0xbfb8aa3b, v41
  v_mul_f32 v50, 0xbfb8aa3b, v42
  v_mul_f32 v51, 0xbfb8aa3b, v43
  v_exp_f32 v48, v48
  v_exp_f32 v49, v49
  v_exp_f32 v50, v50
  v_exp_f32 v51, v51
  v_add_f32 v48, 1.0, v48
  v_add_f32 v49, 1.0, v49
  v_add_f32 v50, 1.0, v50
  v_add_f32 v51, 1.0, v51
  v_rcp_f32 v48, v48
  v_rcp_f32 v49, v49
  v_rcp_f32 v50, v50
  v_rcp_f32 v51, v51
  v_mul_f32 v40, v40, v48
  v_mul_f32 v41, v41, v49
  v_mul_f32 v42, v42, v50
  v_mul_f32 v43, v43, v51
  v_cvt_pk_bf16_f32 v40, v40, v41
  v_cvt_pk_bf16_f32 v42, v42, v43
  v_and_b32 v41, s9, v40
  v_lshlrev_b32 v40, 16, v40
  v_and_b32 v43, s9, v42
  v_lshlrev_b32 v42, 16, v42
  v_mul_f32 v40, v40, v44
  v_mul_f32 v41, v41, v45
  v_mul_f32 v42, v42, v46
  v_mul_f32 v43, v43, v47
  v_cvt_pk_bf16_f32 v40, v40, v41
  v_cvt_pk_bf16_f32 v41, v42, v43
  v_lshlrev_b32 v25, 3, v0
  s_mov_b64 exec, 0xffff
  ds_write_b64 v25, v[40:41] offset:7168
  s_mov_b64 exec, -1
L_noh_31:
  v_lshrrev_b32 v16, 5, v0
  v_and_b32 v17, 31, v0
  v_add_u32 v18, 0, v16
  v_lshlrev_b32 v18, 1, v18
  v_xor_b32 v18, v18, v17
  v_lshlrev_b32 v18, 4, v18
  v_lshlrev_b32 v19, 10, v16
  v_add_u32 v20, v18, v19
  v_add_u32 v18, 2, v16
  v_lshlrev_b32 v18, 1, v18
  v_xor_b32 v18, v18, v17
  v_lshlrev_b32 v18, 4, v18
  v_lshlrev_b32 v19, 10, v16
  v_add_u32 v21, v18, v19
  v_add_u32 v18, 4, v16
  v_lshlrev_b32 v18, 1, v18
  v_xor_b32 v18, v18, v17
  v_lshlrev_b32 v18, 4, v18
  v_lshlrev_b32 v19, 10, v16
  v_add_u32 v22, v18, v19
  v_add_u32 v18, 6, v16
  v_lshlrev_b32 v18, 1, v18
  v_xor_b32 v18, v18, v17
  v_lshlrev_b32 v18, 4, v18
  v_lshlrev_b32 v19, 10, v16
  v_add_u32 v23, v18, v19
  s_mov_b32 s44, s24
  s_mov_b32 s45, s25
  s_mov_b32 s46, 0x400000
  s_mov_b32 s47, 0x00020000
  s_mov_b32 s48, s32
  s_mov_b32 s49, s33
  s_mov_b32 s50, 0x1c0000
  s_mov_b32 s51, 0x00020000
  s_lshl_b32 s9, s3, 2
  s_add_u32 s9, s9, s65
  s_lshl_b32 s9, s9, 7
  s_lshl_b32 s10, s66, 1
  s_add_u32 s9, s9, s10
  s_lshl_b32 s9, s9, 10
  s_lshl_b32 s10, s67, 9
  s_add_u32 s14, s9, s10
  s_lshl_b32 s11, s43, 14
  s_add_u32 s11, s11, s10
  s_cmp_eq_u32 s92, 0
  s_cbranch_scc1 L_wcd_35
  ds_read_b32 v18, v1
  v_mov_b32 v16, s8
  v_mov_b32 v17, s4
  v_lshlrev_b32 v17, 2, v17
  s_waitcnt lgkmcnt(0)
  v_readfirstlane_b32 s9, v18
  s_nop 0
  s_cmp_lg_u32 s9, 3
  s_cbranch_scc1 L_wcd_35
  s_mov_b64 exec, 1
  buffer_store_dword v16, v17, s[52:55], s96 offen
  s_mov_b64 exec, -1
  s_mov_b32 s13, 16
L_wc_34:
  s_cmp_ge_u32 s97, 28
  s_cbranch_scc1 L_wcd_35
  s_sleep 2
  buffer_load_dword v56, v57, s[52:55], s96 offen sc1
  s_sub_u32 s13, s13, 1
  s_waitcnt vmcnt(0)
  v_cmp_eq_u32 vcc, s8, v56
  s_nop 1
  s_bcnt1_i32_b32 s97, vcc_lo
  s_cmp_lg_u32 s13, 0
  s_cbranch_scc1 L_wc_34
L_wcd_35:
  s_mov_b32 s13, 400000
L_cspin_36:
  ds_read_b32 v16, v1 offset:8
  s_waitcnt lgkmcnt(0)
  v_readfirstlane_b32 s9, v16
  s_nop 0
  s_cmp_ge_u32 s9, 7
  s_cbranch_scc1 L_cdone_37
  s_sleep 2
  s_sub_u32 s13, s13, 1
  s_cmp_lg_u32 s13, 0
  s_cbranch_scc1 L_cspin_36
L_cdone_37:
  s_cmp_ge_u32 s42, 14
  s_cbranch_scc1 L_nowd_38
  s_mov_b32 m0, 0xe000
  s_nop 0
  buffer_load_dwordx4 v20, s[48:51], s11 offen nt lds
  s_mov_b32 m0, 0xe400
  s_add_u32 s11, s11, 0x800
  buffer_load_dwordx4 v21, s[48:51], s11 offen nt lds
  s_mov_b32 m0, 0xe800
  s_add_u32 s11, s11, 0x800
  buffer_load_dwordx4 v22, s[48:51], s11 offen nt lds
  s_mov_b32 m0, 0xec00
  s_add_u32 s11, s11, 0x800
  buffer_load_dwordx4 v23, s[48:51], s11 offen nt lds
  s_mov_b32 m0, 0xf000
  s_add_u32 s11, s11, 0x800
  buffer_load_dwordx4 v20, s[48:51], s11 offen nt lds
  s_mov_b32 m0, 0xf400
  s_add_u32 s11, s11, 0x800
  buffer_load_dwordx4 v21, s[48:51], s11 offen nt lds
  s_mov_b32 m0, 0xf800
  s_add_u32 s11, s11, 0x800
  buffer_load_dwordx4 v22, s[48:51], s11 offen nt lds
  s_mov_b32 m0, 0xfc00
  s_add_u32 s11, s11, 0x800
  buffer_load_dwordx4 v23, s[48:51], s11 offen nt lds
L_nowd_38:
  s_mov_b32 m0, 0xa000
  s_nop 0
  buffer_load_dwordx4 v20, s[44:47], s14 offen nt lds
  s_mov_b32 m0, 0xa400
  s_add_u32 s14, s14, 0x2000
  buffer_load_dwordx4 v21, s[44:47], s14 offen nt lds
  s_mov_b32 m0, 0xa800
  s_add_u32 s14, s14, 0x2000
  buffer_load_dwordx4 v22, s[44:47], s14 offen nt lds
  s_mov_b32 m0, 0xac00
  s_add_u32 s14, s14, 0x2000
  buffer_load_dwordx4 v23, s[44:47], s14 offen nt lds
  s_mov_b32 m0, 0xb000
  s_add_u32 s14, s14, 0x2000
  buffer_load_dwordx4 v20, s[44:47], s14 offen nt lds
  s_mov_b32 m0, 0xb400
  s_add_u32 s14, s14, 0x2000
  buffer_load_dwordx4 v21, s[44:47], s14 offen nt lds
  s_mov_b32 m0, 0xb800
  s_add_u32 s14, s14, 0x2000
  buffer_load_dwordx4 v22, s[44:47], s14 offen nt lds
  s_mov_b32 m0, 0xbc00
  s_add_u32 s14, s14, 0x2000
  buffer_load_dwordx4 v23, s[44:47], s14 offen nt lds
  s_mov_b32 m0, 0xc000
  s_add_u32 s14, s14, 0x2000
  buffer_load_dwordx4 v20, s[44:47], s14 offen nt lds
  s_mov_b32 m0, 0xc400
  s_add_u32 s14, s14, 0x2000
  buffer_load_dwordx4 v21, s[44:47], s14 offen nt lds
  s_mov_b32 m0, 0xc800
  s_add_u32 s14, s14, 0x2000
  buffer_load_dwordx4 v22, s[44:47], s14 offen nt lds
  s_mov_b32 m0, 0xcc00
  s_add_u32 s14, s14, 0x2000
  buffer_load_dwordx4 v23, s[44:47], s14 offen nt lds
  s_mov_b32 m0, 0xd000
  s_add_u32 s14, s14, 0x2000
  buffer_load_dwordx4 v20, s[44:47], s14 offen nt lds
  s_mov_b32 m0, 0xd400
  s_add_u32 s14, s14, 0x2000
  buffer_load_dwordx4 v21, s[44:47], s14 offen nt lds
  s_mov_b32 m0, 0xd800
  s_add_u32 s14, s14, 0x2000
  buffer_load_dwordx4 v22, s[44:47], s14 offen nt lds
  s_mov_b32 m0, 0xdc00
  s_add_u32 s14, s14, 0x2000
  buffer_load_dwordx4 v23, s[44:47], s14 offen nt lds
  v_lshrrev_b32 v24, 1, v0
  v_lshlrev_b32 v24, 13, v24
  v_and_b32 v25, 1, v0
  v_lshlrev_b32 v25, 4, v25
  v_add_u32 v24, v24, v25
  s_lshl_b32 s60, s3, 3
  s_lshr_b32 s9, s2, 5
  s_add_u32 s60, s60, s9
  s_lshl_b32 s60, s60, 2
  s_and_b32 s9, s4, 3
  s_add_u32 s60, s60, s9
  s_lshl_b32 s9, s60, 5
  s_add_u32 s9, s9, 0x200000
  s_add_u32 s56, s9, 0x0
  s_add_u32 s57, s9, 0x40000
  s_add_u32 s58, s9, 0x80000
  s_add_u32 s59, s9, 0xc0000
  v_lshrrev_b32 v14, 4, v0
  v_lshlrev_b32 v14, 10, v14
  s_waitcnt lgkmcnt(0)
  s_barrier
  v_mov_b32 v2, 0x100
  s_waitcnt vmcnt(16)
  s_mov_b64 exec, 1
  ds_add_u32 v1, v2 offset:8
  s_waitcnt vmcnt(0)
  ds_add_u32 v1, v2 offset:8
  s_mov_b64 exec, -1
  s_mov_b32 s48, s36
  s_mov_b32 s49, s37
  s_mov_b32 s50, 0x1000
  s_mov_b32 s51, 0x00020000
  s_barrier
  s_barrier
  s_sleep 14
  s_mov_b32 s13, 20000
  s_nop 1
  buffer_load_dwordx4 v[56:59], v24, s[52:55], s56 offen sc1
  buffer_load_dwordx4 v[60:63], v24, s[52:55], s57 offen sc1
  buffer_load_dwordx4 v[64:67], v24, s[52:55], s58 offen sc1
  buffer_load_dwordx4 v[68:71], v24, s[52:55], s59 offen sc1
  s_sleep 5
  buffer_load_dwordx4 v[72:75], v24, s[52:55], s56 offen sc1
  buffer_load_dwordx4 v[76:79], v24, s[52:55], s57 offen sc1
  buffer_load_dwordx4 v[80:83], v24, s[52:55], s58 offen sc1
  buffer_load_dwordx4 v[84:87], v24, s[52:55], s59 offen sc1
L_pp_39:
  s_waitcnt vmcnt(4)
  v_xor_b32 v40, s72, v56
  v_xor_b32 v41, s73, v57
  v_xor_b32 v42, s74, v58
  v_xor_b32 v43, s75, v59
  v_xor_b32 v44, s72, v60
  v_xor_b32 v45, s73, v61
  v_xor_b32 v46, s74, v62
  v_xor_b32 v47, s75, v63
  v_xor_b32 v48, s72, v64
  v_xor_b32 v49, s73, v65
  v_xor_b32 v50, s74, v66
  v_xor_b32 v51, s75, v67
  v_xor_b32 v52, s72, v68
  v_xor_b32 v53, s73, v69
  v_xor_b32 v54, s74, v70
  v_xor_b32 v55, s75, v71
  v_or3_b32 v16, v40, v41, v42
  v_or3_b32 v16, v16, v43, v44
  v_or3_b32 v16, v16, v45, v46
  v_or_b32 v16, v16, v47
  v_or3_b32 v17, v48, v49, v50
  v_or3_b32 v17, v17, v51, v52
  v_or3_b32 v17, v17, v53, v54
  v_or_b32 v17, v17, v55
  v_or_b32 v16, v16, v17
  v_and_b32 v16, 0x3ff, v16
  v_cmp_ne_u32 vcc, 0, v16
  s_nop 1
  s_and_b64 exec, exec, vcc
  s_cbranch_execz L_ppd_40
  buffer_load_dwordx4 v[56:59], v24, s[52:55], s56 offen sc1
  buffer_load_dwordx4 v[60:63], v24, s[52:55], s57 offen sc1
  buffer_load_dwordx4 v[64:67], v24, s[52:55], s58 offen sc1
  buffer_load_dwordx4 v[68:71], v24, s[52:55], s59 offen sc1
  s_waitcnt vmcnt(4)
  v_xor_b32 v40, s72, v72
  v_xor_b32 v41, s73, v73
  v_xor_b32 v42, s74, v74
  v_xor_b32 v43, s75, v75
  v_xor_b32 v44, s72, v76
  v_xor_b32 v45, s73, v77
  v_xor_b32 v46, s74, v78
  v_xor_b32 v47, s75, v79
  v_xor_b32 v48, s72, v80
  v_xor_b32 v49, s73, v81
  v_xor_b32 v50, s74, v82
  v_xor_b32 v51, s75, v83
  v_xor_b32 v52, s72, v84
  v_xor_b32 v53, s73, v85
  v_xor_b32 v54, s74, v86
  v_xor_b32 v55, s75, v87
  v_or3_b32 v16, v40, v41, v42
  v_or3_b32 v16, v16, v43, v44
  v_or3_b32 v16, v16, v45, v46
  v_or_b32 v16, v16, v47
  v_or3_b32 v17, v48, v49, v50
  v_or3_b32 v17, v17, v51, v52
  v_or3_b32 v17, v17, v53, v54
  v_or_b32 v17, v17, v55
  v_or_b32 v16, v16, v17
  v_and_b32 v16, 0x3ff, v16
  v_cmp_ne_u32 vcc, 0, v16
  s_nop 1
  s_and_b64 exec, exec, vcc
  s_cbranch_execz L_ppd_40
  buffer_load_dwordx4 v[72:75], v24, s[52:55], s56 offen sc1
  buffer_load_dwordx4 v[76:79], v24, s[52:55], s57 offen sc1
  buffer_load_dwordx4 v[80:83], v24, s[52:55], s58 offen sc1
  buffer_load_dwordx4 v[84:87], v24, s[52:55], s59 offen sc1
  s_sub_u32 s13, s13, 1
  s_cmp_lg_u32 s13, 0
  s_cbranch_scc1 L_pp_39
L_ppd_40:
  s_mov_b64 exec, -1
  v_pk_add_f32 v[40:41], v[40:41], v[44:45]
  v_pk_add_f32 v[42:43], v[42:43], v[46:47]
  v_pk_add_f32 v[48:49], v[48:49], v[52:53]
  v_pk_add_f32 v[50:51], v[50:51], v[54:55]
  v_pk_add_f32 v[40:41], v[40:41], v[48:49]
  v_pk_add_f32 v[42:43], v[42:43], v[50:51]
  s_nop 0
  v_permlane16_swap_b32 v40, v41
  v_permlane16_swap_b32 v42, v43
  v_add_f32 v40, v40, v41
  v_add_f32 v42, v42, v43
  s_nop 1
  v_permlane32_swap_b32 v40, v42
  v_add_f32 v40, v40, v42
  s_nop 1
  v_add_f32_dpp v40, v40, v40 row_ror:2 row_mask:0xf bank_mask:0xf
  s_nop 1
  v_add_f32_dpp v40, v40, v40 row_ror:4 row_mask:0xf bank_mask:0xf
  s_nop 1
  v_add_f32_dpp v40, v40, v40 row_ror:8 row_mask:0xf bank_mask:0xf
  s_nop 1
  v_mov_b32_dpp v41, v40 quad_perm:[1,0,3,2] row_mask:0xf bank_mask:0xf
  v_cvt_pk_bf16_f32 v40, v40, v41
  s_lshl_b32 s9, s60, 2
  s_mov_b32 exec_lo, 0x00010001
  s_mov_b32 exec_hi, exec_lo
  buffer_store_dword v40, v14, s[48:51], s9 offen
  s_cmp_lg_u32 s2, 0
  s_cbranch_scc1 L_noe_41
  s_mov_b64 exec, 1
  v_mov_b32 v15, s8
  v_mov_b32 v16, 0
  buffer_store_dword v15, v16, s[52:55], 0 offen sc1
L_noe_41:
  s_mov_b64 exec, -1
L_end:
  s_endpgm
.section .rodata,"a"
.p2align 6
.amdhsa_kernel gated_mix__gqa_block_cached__swiglu_ffn__decode_kernel
  .amdhsa_next_free_vgpr 168
  .amdhsa_next_free_sgpr 102
  .amdhsa_accum_offset 104
  .amdhsa_group_segment_fixed_size 0
  .amdhsa_kernarg_size 104
  .amdhsa_user_sgpr_count 2
  .amdhsa_user_sgpr_kernarg_segment_ptr 1
  .amdhsa_system_sgpr_workgroup_id_x 1
.end_amdhsa_kernel
```
